```python
import torch

def _softmax(x, axis=-1):
    return torch.softmax(x, dim=axis)
def _gelu(x):
    return torch.nn.functional.gelu(x, approximate="tanh")
def _silu(x):
    return torch.nn.functional.silu(x)
def _sigmoid(x):
    return torch.sigmoid(x)
def _layernorm(x, axis=-1, eps=1e-5):
    m = x.mean(dim=axis, keepdim=True)
    v = x.var(dim=axis, keepdim=True, unbiased=False)
    return (x - m) / torch.sqrt(v + eps)
def _scatter_add(tgt, idx, src, axis=0):
    return tgt.clone().index_add_(axis, idx, src)
def _segment_sum(src, seg, n):
    out = torch.zeros((n,) + src.shape[1:], dtype=src.dtype)
    return out.index_add_(0, seg, src)
def _pad(x, pw):
    flat = tuple(v for pair in reversed(pw) for v in pair)
    return torch.nn.functional.pad(x, flat)

kernel_name = 'sequential_preLN__sliding_block_cached__glu_gated_glu__decode'

def setup_inputs():

    _w = (lambda a: (lambda t: t.to(torch.bfloat16) if t.is_floating_point() else t)(torch.as_tensor(a)))
    def _A_setup():
        B, Sq, D = 8, 1, 512
        Hq, Hkv, Sk, Dh = 32, 8, 4096, 128
        assert Hq % Hkv == 0, (Hq, Hkv)
        return {
            "x": _w((lambda *s: torch.randn(*s, dtype=torch.bfloat16) * 0.05)(B, Sq, D)),
            "k_cache": _w((lambda *s: torch.randn(*s, dtype=torch.bfloat16) * 3.2)(B, Hkv, Sk, Dh)),
            "v_cache": _w((lambda *s: torch.randn(*s, dtype=torch.bfloat16) * 0.4)(B, Hkv, Sk, Dh)),
            "wq": _w((lambda *s: torch.randn(*s, dtype=torch.bfloat16) * 3.2)(D, Hq * Dh) * (D ** -0.5)),
            "wo": _w((lambda *s: torch.randn(*s, dtype=torch.bfloat16) * 0.4)(Hq * Dh, D) * ((Hq * Dh) ** -0.5)),
        }
    _A_in = _A_setup()

    def _B_setup():
        B, S, D, F = 8, 1, 512, 1792
        return {
            "x": _w((lambda *s: torch.randn(*s, dtype=torch.bfloat16) * 0.05)(B, S, D)),
            "w_gate": _w((lambda *s: torch.randn(*s, dtype=torch.bfloat16) * 0.1)(D, F)),
            "w_up": _w((lambda *s: torch.randn(*s, dtype=torch.bfloat16) * 0.05)(D, F)),
            "w_down": _w((lambda *s: torch.randn(*s, dtype=torch.bfloat16) * 0.05)(F, D)),
        }
    _B_in = _B_setup()

    return {
        "A_x": _A_in["x"],
        "A_k_cache": _A_in["k_cache"],
        "A_v_cache": _A_in["v_cache"],
        "A_wq": _A_in["wq"],
        "A_wo": _A_in["wo"],
        "B_x": _B_in["x"],
        "B_w_gate": _B_in["w_gate"],
        "B_w_up": _B_in["w_up"],
        "B_w_down": _B_in["w_down"],
    }

def reference(A_x, A_k_cache, A_v_cache, A_wq, A_wo, B_x, B_w_gate, B_w_up, B_w_down):
    def _A_ref(x, k_cache, v_cache, wq, wo):
        B, Sq, D = x.shape
        Hq, Dh = 32, 128
        Hkv, Sk = k_cache.shape[1], k_cache.shape[2]
        W = min(4096, max(256, Sk // 4))
        rep = Hq // Hkv
        q = (lambda x, *d: x.permute(*d))((x @ wq).reshape(B, Sq, Hq, Dh), 0, 2, 1, 3)
        k = (lambda x, n, axis: torch.repeat_interleave(x, n, dim=axis))(k_cache[:, :, Sk - W:, :], rep, axis=1)
        v = (lambda x, n, axis: torch.repeat_interleave(x, n, dim=axis))(v_cache[:, :, Sk - W:, :], rep, axis=1)
        scores = torch.einsum("bhqd,bhkd->bhqk", q, k) * (Dh ** -0.5)
        p = _softmax(scores, axis=-1)
        o = torch.einsum("bhqk,bhkd->bhqd", p, v)
        return (lambda x, *d: x.permute(*d))(o, 0, 2, 1, 3).reshape(B, Sq, Hq * Dh) @ wo

    def _B_ref(x, w_gate, w_up, w_down):
        g = torch.einsum("bsd,df->bsf", x, w_gate)
        u = torch.einsum("bsd,df->bsf", x, w_up)
        h = _sigmoid(g) * u
        return torch.einsum("bsf,fd->bsd", h, w_down)

    x = A_x
    h = x + _A_ref(_layernorm(x, axis=-1), A_k_cache, A_v_cache, A_wq, A_wo)
    h2 = h + _B_ref(_layernorm(h, axis=-1), B_w_gate, B_w_up, B_w_down)
    return h2
```

```asm
; @launch grid=(256,1,1) block=(640,1,1) lds=163840
.amdgcn_target "amdgcn-amd-amdhsa--gfx950"
.text
.globl sequential_preLN__sliding_block_cached__glu_gated_glu__decode_kernel
.p2align 8
.type sequential_preLN__sliding_block_cached__glu_gated_glu__decode_kernel,@function
sequential_preLN__sliding_block_cached__glu_gated_glu__decode_kernel:
  s_load_dwordx16 s[4:19], s[0:1], 0
  s_load_dwordx8 s[20:27], s[0:1], 64
  v_readfirstlane_b32 s3, v0
  s_lshr_b32 s31, s2, 8
  s_cbranch_scc1 L_END
  s_and_b32 s28, s2, 7
  s_lshr_b32 s3, s3, 6
  s_cbranch_scc1 L_COMP
  s_getpc_b64 s[62:63]
L_PC:
  v_lshlrev_b32 v26, 7, v0
  v_mov_b32 v27, 0
  v_lshl_add_u64 v[28:29], v[26:27], 0, s[62:63]
  global_load_dword v40, v[28:29], off
  v_add_u32 v26, L_LAST-L_PC-8064, v26
  v_lshl_add_u64 v[28:29], v[26:27], 0, s[62:63]
  global_load_dword v41, v[28:29], off
  v_lshrrev_b32 v30, 3, v0
  v_and_b32 v22, 2, v30
  v_xor_b32 v22, v22, v0
  v_and_b32 v22, 7, v22
  v_lshlrev_b32 v22, 4, v22
  v_lshl_or_b32 v24, v30, 13, v22
  s_lshr_b32 s60, s2, 6
  s_lshl_b32 s60, s60, 10
  s_add_u32 s60, s60, s28
  s_lshl_b32 s60, s60, 10
  s_and_b32 s61, s2, 56
  s_lshl4_add_u32 s60, s61, s60
  s_mov_b32 s47, 0x20000
  s_mov_b32 m0, s47
  s_lshl_b32 s46, s47, 5
  v_xor_b32 v25, 64, v24
  v_add_u32 v25, 64512, v25
  s_waitcnt lgkmcnt(0)
  s_mov_b32 s44, s10
  s_mov_b32 s45, s11
S_1:
  buffer_load_dwordx4 v24, s[44:47], s60 offen nt lds
  buffer_load_dwordx4 v25, s[44:47], s60 offen offset:1024 nt lds
  s_add_u32 m0, m0, 2048
  s_add_u32 s60, s60, 131072
  s_cmp_lg_u32 m0, 147456
  s_cbranch_scc1 S_1
  s_setprio 3
  v_mov_b32 v3, 158720
  s_lshr_b32 s29, s2, 3
  s_mov_b32 s30, 0x40000
  s_mul_i32 s34, s2, 2654435
  s_lshr_b32 s34, s34, 9
  s_and_b32 s34, s34, 62
  s_lshr_b32 s56, s2, 6
  s_lshl3_add_u32 s56, s56, s28
  s_cmp_ge_u32 s56, 28
  s_cselect_b32 s35, 1, 0
  v_and_b32 v1, 15, v0
  v_lshrrev_b32 v2, 4, v0
  v_lshlrev_b32 v20, 1, v2
  v_xor_b32 v20, v20, v1
  v_lshlrev_b32 v20, 4, v20
  v_lshl_or_b32 v20, v2, 8, v20
  v_xor_b32 v21, 0x80, v20
  s_lshr_b32 s65, s29, 2
  s_lshl3_add_u32 s65, s65, s28
  s_lshl_b32 s65, s65, 4
  s_and_b32 s66, s29, 3
  s_add_u32 s65, s65, s66
  s_add_u32 s65, s65, 12
  s_lshl_b32 s65, s65, 16
  v_lshl_add_u32 v32, v1, 2, v3
  v_mov_b32 v31, 0
  ds_write_b32 v32, v31
  s_mov_b32 s36, s6
  s_mov_b32 s37, s7
  s_mov_b32 s38, 67108864
  s_mov_b32 s39, 0x20000
  s_lshl_b32 s66, s34, 10
  s_mov_b32 s67, 4
S_2:
  s_add_u32 m0, s66, 0
  s_add_u32 s68, s66, s65
  buffer_load_dwordx4 v20, s[36:39], s68 offen nt lds
  buffer_load_dwordx4 v21, s[36:39], s68 offen offset:1024 nt lds
  s_add_u32 s66, s66, 2048
  s_and_b32 s66, s66, 0xffff
  s_sub_u32 s67, s67, 1
  s_cmp_lg_u32 s67, 0
  s_cbranch_scc1 S_2
  v_xor_b32 v23, 64, v22
  s_lshl_b32 s61, s61, 4
  s_and_b32 s32, s29, 7
  s_mov_b32 s94, s56
  v_mov_b32 v31, 64
  s_waitcnt lgkmcnt(0)
  s_barrier
  s_mov_b32 s67, 28
S_3:
  s_add_u32 m0, s66, 0
  s_add_u32 s68, s66, s65
  buffer_load_dwordx4 v20, s[36:39], s68 offen nt lds
  buffer_load_dwordx4 v21, s[36:39], s68 offen offset:1024 nt lds
  s_add_u32 s66, s66, 2048
  s_and_b32 s66, s66, 0xffff
  s_sub_u32 s67, s67, 1
  v_add_u32 v31, 2, v31
  s_waitcnt vmcnt(24)
  ds_write_b32 v3, v31 offset:0
  s_cmp_lg_u32 s67, 0
  s_cbranch_scc1 S_3
  v_lshl_or_b32 v26, v30, 10, v22
  v_lshl_or_b32 v27, v30, 10, v23
  v_add_u32 v27, 7168, v27
  v_mul_u32_u24 v30, 3584, v30
  v_add_u32 v28, v30, v22
  v_add_u32 v29, v30, v23
  v_add_u32 v29, 27648, v29
  s_lshl_b32 s62, s28, 19
  s_lshr_b32 s63, s29, 3
  s_lshl_b32 s63, s63, 17
  s_add_u32 s62, s62, s63
  s_add_u32 s62, s62, s61
  s_lshl_b32 s63, s94, 16
  s_add_u32 s63, s63, s61
  s_lshr_b32 s64, s32, 1
  s_mul_i32 s64, s64, 458752
  s_lshl_b32 s69, s94, 7
  s_add_u32 s64, s64, s69
  s_mov_b32 s40, s8
  s_mov_b32 s41, s9
  s_mov_b32 s42, 67108864
  s_mov_b32 s43, 0x20000
  s_mov_b32 s48, s12
  s_mov_b32 s49, s13
  s_mov_b32 s50, 4194304
  s_mov_b32 s51, 0x20000
  s_mov_b32 s72, s20
  s_mov_b32 s73, s21
  s_mov_b32 s74, 1835008
  s_mov_b32 s75, 0x20000
  s_and_b32 s31, s29, 1
  s_cmp_eq_u32 s31, 0
  s_cselect_b32 s52, s16, s18
  s_cselect_b32 s53, s17, s19
  s_mov_b32 s54, 1835008
  s_mov_b32 s55, 0x20000
  s_lshl_b32 s66, s34, 10
  s_mov_b32 s67, 16
S_4:
  s_add_u32 m0, s66, 65536
  s_add_u32 s68, s66, s65
  buffer_load_dwordx4 v20, s[40:43], s68 offen nt lds
  buffer_load_dwordx4 v21, s[40:43], s68 offen offset:1024 nt lds
  s_add_u32 s66, s66, 2048
  s_and_b32 s66, s66, 0xffff
  s_sub_u32 s67, s67, 1
  v_add_u32 v31, 2, v31
  s_waitcnt vmcnt(24)
  ds_write_b32 v3, v31 offset:0
  s_cmp_lg_u32 s67, 0
  s_cbranch_scc1 S_4
  v_add_u32 v31, -8, v31
  s_mov_b32 s67, 16
S_5:
  s_add_u32 m0, s66, 65536
  s_add_u32 s68, s66, s65
  buffer_load_dwordx4 v20, s[40:43], s68 offen nt lds
  buffer_load_dwordx4 v21, s[40:43], s68 offen offset:1024 nt lds
  s_add_u32 s66, s66, 2048
  s_and_b32 s66, s66, 0xffff
  s_sub_u32 s67, s67, 1
  v_add_u32 v31, 2, v31
  s_waitcnt vmcnt(32)
  ds_write_b32 v3, v31 offset:0
  s_cmp_lg_u32 s67, 0
  s_cbranch_scc1 S_5
W_6:
  ds_read_b32 v11, v3 offset:12
  s_waitcnt lgkmcnt(0)
  v_readfirstlane_b32 s31, v11
  s_cmp_ge_u32 s31, 4
  s_cbranch_scc1 W_7
  s_sleep 1
  s_sub_u32 s30, s30, 1
  s_cmp_gt_i32 s30, 0
  s_cbranch_scc1 W_6
W_7:
  s_mov_b32 m0, 131072
  s_nop 0
S_8:
  buffer_load_dwordx4 v26, s[48:51], s62 offen nt lds
  buffer_load_dwordx4 v27, s[48:51], s62 offen offset:1024 nt lds
  s_add_u32 m0, m0, 2048
  s_add_u32 s62, s62, 16384
  v_add_u32 v31, 2, v31
  s_waitcnt vmcnt(32)
  ds_write_b32 v3, v31 offset:0
  s_cmp_lg_u32 m0, 147456
  s_cbranch_scc1 S_8
  v_add_u32 v31, 2, v31
  s_waitcnt vmcnt(30)
  ds_write_b32 v3, v31 offset:0
  v_add_u32 v31, 2, v31
  s_waitcnt vmcnt(28)
  ds_write_b32 v3, v31 offset:0
  v_add_u32 v31, 2, v31
  s_waitcnt vmcnt(26)
  ds_write_b32 v3, v31 offset:0
  v_add_u32 v31, 2, v31
  s_waitcnt vmcnt(24)
  ds_write_b32 v3, v31 offset:0
  v_add_u32 v31, 2, v31
  s_waitcnt vmcnt(22)
  ds_write_b32 v3, v31 offset:0
  v_add_u32 v31, 2, v31
  s_waitcnt vmcnt(20)
  ds_write_b32 v3, v31 offset:0
  v_add_u32 v31, 2, v31
  s_waitcnt vmcnt(18)
  ds_write_b32 v3, v31 offset:0
  v_mov_b32 v31, 300
  s_waitcnt vmcnt(16)
  s_barrier
  s_waitcnt vmcnt(0)
  ds_write_b32 v3, v31 offset:0
  s_cmp_eq_u32 s35, 1
  s_cbranch_scc1 L_LX
W_9:
  ds_read_b32 v11, v3 offset:28
  s_waitcnt lgkmcnt(0)
  v_readfirstlane_b32 s31, v11
  s_cmp_ge_u32 s31, 2
  s_cbranch_scc1 W_10
  s_sub_u32 s30, s30, 1
  s_cmp_gt_i32 s30, 0
  s_cbranch_scc1 W_9
W_10:
  s_mov_b32 m0, 0
  v_mov_b32 v31, 310
S_11:
  buffer_load_dwordx4 v28, s[52:55], s64 offen nt lds
  buffer_load_dwordx4 v29, s[52:55], s64 offen offset:1024 nt lds
  s_add_u32 m0, m0, 2048
  s_add_u32 s64, s64, 57344
  s_cmp_lg_u32 m0, 16384
  s_cbranch_scc1 S_11
  s_waitcnt vmcnt(0)
  ds_write_b32 v3, v31 offset:0
W_12:
  ds_read_b32 v11, v3 offset:60
  s_waitcnt lgkmcnt(0)
  v_readfirstlane_b32 s31, v11
  s_cmp_ge_u32 s31, 1
  s_cbranch_scc1 W_13
  s_sub_u32 s30, s30, 1
  s_cmp_gt_i32 s30, 0
  s_cbranch_scc1 W_12
W_13:
  s_mov_b32 m0, 16384
  v_mov_b32 v32, 320
S_14:
  buffer_load_dwordx4 v26, s[72:75], s63 offen nt lds
  buffer_load_dwordx4 v27, s[72:75], s63 offen offset:1024 nt lds
  s_add_u32 m0, m0, 2048
  s_add_u32 s63, s63, 16384
  s_cmp_lg_u32 m0, 24576
  s_cbranch_scc1 S_14
  s_waitcnt vmcnt(0)
  ds_write_b32 v3, v32 offset:0
L_LX:
  s_waitcnt lgkmcnt(0)
L_END:
  s_endpgm
  .p2align 6
L_COMP:
  v_and_b32 v0, 63, v0
  s_sub_u32 s3, s3, 1
  v_lshlrev_b32 v20, 4, v0
  s_and_b32 s31, s3, 7
  s_lshl_b32 s31, s31, 10
  s_movk_i32 s42, 0x2000
  s_mov_b32 s43, 0x20000
  s_waitcnt lgkmcnt(0)
  s_mov_b32 s40, s4
  s_mov_b32 s41, s5
  buffer_load_dwordx4 v[24:27], v20, s[40:43], s31 offen
  s_load_dword s49, s[26:27], 0
  v_mov_b32 v3, 158720
  s_lshr_b32 s29, s2, 3
  s_mov_b32 s30, 0x40000
  s_mul_i32 s34, s2, 2654435
  s_lshr_b32 s34, s34, 9
  s_and_b32 s34, s34, 62
  s_lshr_b32 s56, s2, 6
  s_lshl3_add_u32 s56, s56, s28
  s_cmp_ge_u32 s56, 28
  s_cselect_b32 s35, 1, 0
  v_and_b32 v1, 15, v0
  v_lshrrev_b32 v2, 4, v0
  v_mov_b32 v4, 1
  v_mov_b32 v21, 2147483648
  s_mov_b32 s36, s26
  s_mov_b32 s37, s27
  s_mov_b32 s38, 5242880
  s_mov_b32 s39, 0x20000
  s_cmp_lg_u32 s3, 8
  s_cbranch_scc1 L_NQG
  s_barrier
  s_branch L_QG
L_NQG:
  v_mov_b32 v7, v21
  v_mov_b32 v8, v21
  v_mov_b32 v9, v21
  v_mov_b32 v18, v21
  v_mov_b32 v140, v21
  s_mov_b32 s51, 0
  s_mov_b64 s[52:53], 0
  s_mov_b64 s[54:55], 0
  s_mov_b32 s59, 0
  v_mov_b32 v28, -1
  v_mov_b32 v29, -1
  v_mov_b32 v30, -1
  v_mov_b32 v31, -1
  s_lshl_b32 s31, s28, 5
  s_add_u32 s31, s31, s29
  s_lshl3_add_u32 s31, s31, s3
  s_lshl_b32 s31, s31, 7
  s_add_u32 s31, s31, 655360
  s_mov_b64 exec, 0xff
  buffer_store_dwordx4 v[28:31], v20, s[36:39], s31 offen sc1
  s_cmp_lg_u32 s3, 3
  s_cbranch_scc1 L_NHS
  s_lshl_b32 s31, s2, 8
  s_add_u32 s31, s31, 1572864
  s_mov_b64 exec, 0xffff
  buffer_store_dwordx4 v[28:31], v20, s[36:39], s31 offen sc1
L_NHS:
  s_mov_b64 exec, -1
  v_lshlrev_b32 v6, 13, v1
  v_lshl_or_b32 v6, v2, 3, v6
  v_cmp_gt_u32 vcc, 4, v1
  s_nop 1
  v_cndmask_b32 v6, v21, v6, vcc
  s_lshl_b32 s50, s28, 15
  s_add_u32 s50, s50, 655360
  s_and_b32 s32, s29, 2
  s_lshl_b32 s32, s32, 11
  s_add_u32 s50, s50, s32
  s_lshr_b32 s32, s3, 1
  s_lshl_b32 s32, s32, 10
  s_add_u32 s50, s50, s32
  s_and_b32 s32, s29, 1
  s_lshl_b32 s32, s32, 9
  s_add_u32 s50, s50, s32
  s_lshr_b32 s32, s29, 2
  s_lshl_b32 s32, s32, 6
  s_add_u32 s50, s50, s32
  s_and_b32 s32, s3, 1
  s_lshl_b32 s32, s32, 5
  s_add_u32 s50, s50, s32
  s_barrier
  s_mov_b32 s44, s22
  s_mov_b32 s45, s23
  s_mov_b32 s46, 8192
  s_mov_b32 s47, 0x20000
  s_mov_b32 s4, s36
  s_mov_b32 s5, s37
  s_mov_b32 s6, 0
  s_mov_b32 s7, 0x20000
  s_mov_b32 s8, s36
  s_mov_b32 s9, s37
  s_mov_b32 s10, 0
  s_mov_b32 s11, 0x20000
  s_mov_b32 s66, 0x07060500
  s_mov_b32 s67, 0x07060501
  s_mov_b32 s68, 0x07060502
  s_mov_b32 s69, 0x07060503
  v_bfe_u32 v22, v0, 2, 2
  v_lshl_add_u32 v22, v2, 3, v22
  v_lshlrev_b32 v10, 7, v22
  v_and_b32 v22, 3, v0
  v_lshl_or_b32 v10, v22, 3, v10
  v_bfe_u32 v22, v0, 3, 2
  v_lshl_or_b32 v10, v22, 5, v10
  s_cmp_ge_u32 s3, 4
  s_cbranch_scc1 L_C4
  s_cmp_eq_u32 s3, 2
  s_cbranch_scc1 L_C2
  s_cmp_eq_u32 s3, 3
  s_cbranch_scc1 L_C3
  v_and_b32 v22, 7, v1
  v_lshlrev_b32 v7, 10, v22
  s_and_b32 s31, s29, 7
  s_lshl3_add_u32 s31, s28, s31
  s_lshl_b32 s51, s31, 13
  s_lshl_b32 s31, s3, 9
  s_add_u32 s51, s51, s31
  s_and_b32 s31, s29, 24
  s_lshl4_add_u32 s51, s31, s51
  v_lshrrev_b32 v22, 3, v1
  v_lshl_or_b32 v7, v22, 6, v7
  v_lshl_or_b32 v7, v2, 4, v7
  s_add_u32 s52, s51, 4259840
  s_add_u32 s51, s51, 1048576
  s_lshl_b32 s31, s3, 6
  v_xor_b32 v10, s31, v10
  v_lshlrev_b32 v8, 9, v0
  v_cmp_gt_u32 vcc, 4, v0
  s_nop 1
  v_cndmask_b32 v8, v21, v8, vcc
  s_lshl_b32 s59, s28, 11
  s_and_b32 s31, s29, 3
  s_lshl_b32 s31, s31, 7
  s_add_u32 s59, s59, s31
  s_and_b32 s31, s29, 28
  s_lshl_b32 s31, s31, 2
  s_add_u32 s59, s59, s31
  s_add_u32 s59, s59, 589824
  v_lshlrev_b32 v9, 6, v1
  v_lshl_or_b32 v9, v2, 4, v9
  s_lshl_b32 s32, s28, 2
  s_lshr_b32 s31, s29, 3
  s_add_u32 s32, s32, s31
  s_lshl_b32 s53, s32, 13
  s_add_u32 s53, s53, 655360
  s_add_u32 s54, s53, 4096
  s_lshl_b32 s55, s32, 9
  s_add_u32 s55, s55, 589824
  s_branch L_CD
L_C3:
  s_waitcnt vmcnt(2)
  s_branch L_CE
L_C2:
  v_bfe_u32 v22, v0, 2, 3
  v_lshlrev_b32 v7, 16, v22
  v_lshrrev_b32 v22, 5, v0
  v_lshl_or_b32 v7, v22, 7, v7
  v_lshrrev_b32 v22, 2, v0
  v_and_b32 v23, 3, v0
  v_lshl_or_b32 v7, v23, 4, v7
  v_cmp_gt_u32 vcc, 12, v22
  s_nop 1
  v_cndmask_b32 v8, v21, v7, vcc
  s_lshl_b32 s51, s28, 13
  s_lshr_b32 s31, s29, 1
  s_lshl_b32 s31, s31, 9
  s_add_u32 s51, s51, s31
  s_and_b32 s31, s29, 1
  s_lshl_b32 s31, s31, 6
  s_add_u32 s51, s51, s31
  s_add_u32 s52, s51, 4259840
  s_add_u32 s51, s51, 1048576
  v_lshlrev_b32 v9, 3, v23
  v_lshrrev_b32 v23, 5, v0
  v_lshl_or_b32 v9, v23, 2, v9
  s_lshr_b32 s31, s29, 2
  s_lshl_b32 s31, s31, 10
  s_lshl_b32 s32, s28, 7
  s_add_u32 s31, s31, s32
  s_and_b32 s32, s29, 3
  s_lshl_b32 s32, s32, 5
  s_add_u32 s31, s31, s32
  v_add_u32 v9, s31, v9
  v_and_b32 v23, -5, v9
  v_lshl_or_b32 v18, v22, 13, v23
  v_and_b32 v22, 7, v22
  v_lshl_or_b32 v18, v0, 31, v18
  v_cmp_gt_u32 vcc, 32, v0
  s_nop 1
  v_cndmask_b32 v18, v21, v18, vcc
  s_mov_b32 s59, 1572864
  s_branch L_CD
L_C4:
  v_lshlrev_b32 v22, 4, v2
  v_lshl_or_b32 v7, v1, 8, v22
  v_lshl_or_b32 v9, v1, 13, v22
  v_lshl_or_b32 v18, v1, 10, v22
  v_cmp_gt_u32 vcc, 8, v1
  s_nop 1
  v_cndmask_b32 v7, v21, v7, vcc
  v_cndmask_b32 v9, v21, v9, vcc
  v_cndmask_b32 v18, v21, v18, vcc
  v_cmp_eq_u32 vcc, 0, v1
  s_nop 1
  v_cndmask_b32 v8, v21, v22, vcc
  s_sub_u32 s33, s3, 4
  s_lshl_b32 s31, s56, 3
  s_and_b32 s32, s29, 7
  s_add_u32 s31, s31, s32
  s_lshl_b32 s53, s31, 11
  s_lshl_b32 s54, s31, 8
  s_lshl_b32 s31, s33, 6
  s_add_u32 s53, s53, s31
  s_add_u32 s54, s54, s31
  s_add_u32 s53, s53, 1703936
  s_add_u32 s54, s54, 1638400
  s_lshl_b32 s55, s28, 16
  s_add_u32 s55, s55, s31
  s_lshl_b32 s31, s29, 8
  s_add_u32 s55, s55, s31
  s_add_u32 s55, s55, 65536
  s_mov_b32 s53, s55
  v_mov_b32 v7, v9
  s_lshl_b32 s31, s33, 5
  v_xor_b32 v10, s31, v10
  s_and_b32 s59, s29, 6
  s_lshl_b32 s59, s59, 7
  s_and_b32 s31, s56, 7
  s_lshl_b32 s31, s31, 13
  s_add_u32 s59, s59, s31
  s_add_u32 s59, s59, 1572864
L_CD:
  s_waitcnt vmcnt(1)
L_CE:
  v_lshlrev_b32 v32, 16, v24
  v_and_b32 v33, 0xffff0000, v24
  v_lshlrev_b32 v34, 16, v25
  v_and_b32 v35, 0xffff0000, v25
  v_lshlrev_b32 v36, 16, v26
  v_and_b32 v37, 0xffff0000, v26
  v_lshlrev_b32 v38, 16, v27
  v_and_b32 v39, 0xffff0000, v27
  v_add_f32 v40, v32, v33
  v_add_f32 v42, v34, v35
  v_add_f32 v43, v36, v37
  v_add_f32 v41, v38, v39
  v_add_f32 v40, v40, v42
  v_add_f32 v43, v43, v41
  v_add_f32 v40, v40, v43
  s_nop 1
  v_add_f32_dpp v40, v40, v40 row_ror:8 row_mask:0xf bank_mask:0xf
  s_nop 1
  v_add_f32_dpp v40, v40, v40 row_ror:4 row_mask:0xf bank_mask:0xf
  s_nop 1
  v_add_f32_dpp v40, v40, v40 row_ror:2 row_mask:0xf bank_mask:0xf
  s_nop 1
  v_add_f32_dpp v40, v40, v40 row_ror:1 row_mask:0xf bank_mask:0xf
  v_mov_b32 v42, v40
  s_nop 1
  v_permlane16_swap_b32 v40, v42
  v_add_f32 v40, v40, v42
  v_mov_b32 v42, v40
  s_nop 1
  v_permlane32_swap_b32 v40, v42
  v_add_f32 v40, v40, v42
  v_mul_f32 v40, 0x3b000000, v40
  v_sub_f32 v42, v32, v40
  v_mul_f32 v41, v42, v42
  v_sub_f32 v42, v33, v40
  v_fmac_f32 v41, v42, v42
  v_sub_f32 v42, v34, v40
  v_fmac_f32 v41, v42, v42
  v_sub_f32 v42, v35, v40
  v_fmac_f32 v41, v42, v42
  v_sub_f32 v42, v36, v40
  v_fmac_f32 v41, v42, v42
  v_sub_f32 v42, v37, v40
  v_fmac_f32 v41, v42, v42
  v_sub_f32 v42, v38, v40
  v_fmac_f32 v41, v42, v42
  v_sub_f32 v42, v39, v40
  v_fmac_f32 v41, v42, v42
  s_nop 1
  v_add_f32_dpp v41, v41, v41 row_ror:8 row_mask:0xf bank_mask:0xf
  s_nop 1
  v_add_f32_dpp v41, v41, v41 row_ror:4 row_mask:0xf bank_mask:0xf
  s_nop 1
  v_add_f32_dpp v41, v41, v41 row_ror:2 row_mask:0xf bank_mask:0xf
  s_nop 1
  v_add_f32_dpp v41, v41, v41 row_ror:1 row_mask:0xf bank_mask:0xf
  v_mov_b32 v42, v41
  s_nop 1
  v_permlane16_swap_b32 v41, v42
  v_add_f32 v41, v41, v42
  v_mov_b32 v42, v41
  s_nop 1
  v_permlane32_swap_b32 v41, v42
  v_add_f32 v41, v41, v42
  v_mul_f32 v41, 0x3b000000, v41
  v_cvt_pk_bf16_f32 v42, v40, v41
  v_lshlrev_b32 v40, 16, v42
  v_and_b32 v41, 0xffff0000, v42
  v_add_f32 v41, 0x3727c5ac, v41
  v_cvt_pk_bf16_f32 v41, v41, v41
  v_lshlrev_b32 v41, 16, v41
  v_sqrt_f32 v41, v41
  s_nop 0
  v_cvt_pk_bf16_f32 v41, v41, v41
  v_lshlrev_b32 v41, 16, v41
  v_rcp_f32 v41, v41
  v_sub_f32 v32, v32, v40
  v_sub_f32 v33, v33, v40
  v_cvt_pk_bf16_f32 v24, v32, v33
  v_sub_f32 v34, v34, v40
  v_sub_f32 v35, v35, v40
  v_cvt_pk_bf16_f32 v25, v34, v35
  v_sub_f32 v36, v36, v40
  v_sub_f32 v37, v37, v40
  v_cvt_pk_bf16_f32 v26, v36, v37
  v_sub_f32 v38, v38, v40
  v_sub_f32 v39, v39, v40
  v_cvt_pk_bf16_f32 v27, v38, v39
  v_lshlrev_b32 v32, 16, v24
  v_and_b32 v33, 0xffff0000, v24
  v_lshlrev_b32 v34, 16, v25
  v_and_b32 v35, 0xffff0000, v25
  v_lshlrev_b32 v36, 16, v26
  v_and_b32 v37, 0xffff0000, v26
  v_lshlrev_b32 v38, 16, v27
  v_and_b32 v39, 0xffff0000, v27
  v_mul_f32 v32, v32, v41
  v_mul_f32 v33, v33, v41
  v_mul_f32 v34, v34, v41
  v_mul_f32 v35, v35, v41
  v_mul_f32 v36, v36, v41
  v_mul_f32 v37, v37, v41
  v_mul_f32 v38, v38, v41
  v_mul_f32 v39, v39, v41
  v_cvt_pk_bf16_f32 v24, v32, v33
  v_cvt_pk_bf16_f32 v25, v34, v35
  v_cvt_pk_bf16_f32 v26, v36, v37
  v_cvt_pk_bf16_f32 v27, v38, v39
  s_mul_i32 s31, s3, 1056
  s_add_u32 s31, s31, 147456
  v_add_u32 v22, s31, v20
  ds_write_b128 v22, v[24:27]
  s_waitcnt vmcnt(0)
  s_mov_b64 exec, 1
  ds_add_u32 v3, v4 offset:4
  s_mov_b64 exec, -1
  s_waitcnt lgkmcnt(0)
  s_add_u32 s49, s49, 1
  v_mov_b32 v16, s49
  s_mul_i32 s49, s49, 0x9e3779b1
  v_mov_b32 v15, s49
  s_getreg_b32 s33, hwreg(HW_REG_XCC_ID, 0, 4)
  v_and_b32 v22, 3, v0
  v_lshlrev_b32 v22, 3, v22
  v_bfe_u32 v17, v15, v22, 8
  s_and_b32 s62, s49, 0xff
  s_bfe_u32 s63, s49, 0x80008
  s_bfe_u32 s64, s49, 0x80010
  s_lshr_b32 s65, s49, 24
  s_cmp_lt_u32 s3, 4
  s_cbranch_scc1 L_QN
  v_and_b32 v22, 7, v1
  v_mul_u32_u24 v22, 1056, v22
  v_lshl_add_u32 v22, v2, 4, v22
  s_lshr_b32 s32, s29, 3
  s_lshl_b32 s32, s32, 8
  s_add_u32 s32, s32, 147456
  v_add_u32 v22, s32, v22
  v_add_u32 v23, 131072, v10
  v_not_b32 v24, v15
  v_lshrrev_b32 v25, 1, v1
  v_lshlrev_b32 v25, 14, v25
  v_and_b32 v26, 1, v1
  v_lshl_or_b32 v25, v26, 6, v25
  v_lshl_or_b32 v25, v2, 4, v25
  v_and_b32 v26, 2147483648, v9
  v_or_b32 v25, v25, v26
  s_lshl_b32 s60, s28, 16
  s_and_b32 s31, s29, 2
  s_lshl_b32 s31, s31, 12
  s_add_u32 s60, s60, s31
  s_lshr_b32 s31, s29, 2
  s_lshl_b32 s31, s31, 10
  s_add_u32 s60, s60, s31
  s_and_b32 s31, s29, 1
  s_lshl2_add_u32 s31, s31, s3
  s_lshl_b32 s31, s31, 7
  s_add_u32 s60, s60, s31
  s_add_u32 s60, s60, 4259328
W_15:
  ds_read_b32 v11, v3 offset:0
  s_waitcnt lgkmcnt(0)
  v_readfirstlane_b32 s31, v11
  s_cmp_ge_u32 s31, 80
  s_cbranch_scc1 W_16
  s_sleep 1
  s_sub_u32 s30, s30, 1
  s_cmp_gt_i32 s30, 0
  s_cbranch_scc1 W_15
W_16:
  ds_read_b64_tr_b16 v[64:65], v23 offset:0
  ds_read_b64_tr_b16 v[66:67], v23 offset:512
  ds_read_b64_tr_b16 v[68:69], v23 offset:4096
  ds_read_b64_tr_b16 v[70:71], v23 offset:4608
  ds_read_b64_tr_b16 v[72:73], v23 offset:8192
  ds_read_b64_tr_b16 v[74:75], v23 offset:8704
  ds_read_b64_tr_b16 v[76:77], v23 offset:12288
  ds_read_b64_tr_b16 v[78:79], v23 offset:12800
W_17:
  ds_read_b32 v11, v3 offset:4
  s_waitcnt lgkmcnt(0)
  v_readfirstlane_b32 s31, v11
  s_cmp_ge_u32 s31, 8
  s_cbranch_scc1 W_18
  s_sub_u32 s30, s30, 1
  s_cmp_gt_i32 s30, 0
  s_cbranch_scc1 W_17
W_18:
  s_mov_b64 exec, 1
  ds_add_u32 v3, v4 offset:12
  s_mov_b64 exec, -1
  ds_read_b128 v[48:51], v22 offset:0
  ds_read_b128 v[52:55], v22 offset:64
  ds_read_b128 v[56:59], v22 offset:128
  ds_read_b128 v[60:63], v22 offset:192
  s_waitcnt lgkmcnt(0)
  v_mfma_f32_16x16x32_bf16 v[44:47], v[64:67], v[48:51], 0
  v_mfma_f32_16x16x32_bf16 v[44:47], v[68:71], v[52:55], v[44:47]
  v_mfma_f32_16x16x32_bf16 v[44:47], v[72:75], v[56:59], v[44:47]
  v_mfma_f32_16x16x32_bf16 v[44:47], v[76:79], v[60:63], v[44:47]
  s_nop 7
  v_perm_b32 v44, v44, v24, s66
  v_perm_b32 v45, v45, v24, s67
  v_perm_b32 v46, v46, v24, s68
  v_perm_b32 v47, v47, v24, s69
  v_xor_b32 v44, s33, v44
  buffer_store_dwordx4 v[44:47], v9, s[36:39], s55 offen
  s_add_u32 s55, s55, 4194304
  s_mov_b64 exec, 1
  ds_add_u32 v3, v4 offset:52
  s_mov_b64 exec, -1
  buffer_store_dwordx4 v[44:47], v25, s[36:39], s60 offen sc1
  s_branch L_QK
L_QN:
  s_cmp_lg_u32 s3, 1
  s_cbranch_scc1 L_NWL
  buffer_load_dword v138, v8, s[36:39], s59 offen sc1
L_NWL:
  s_cmp_lg_u32 s3, 3
  s_cbranch_scc1 L_NW3
  s_lshl_b32 s31, s56, 3
  s_and_b32 s32, s29, 7
  s_add_u32 s31, s31, s32
  s_lshl_b32 s32, s31, 8
  s_add_u32 s32, s32, 1638400
  s_lshl_b32 s31, s31, 6
  s_add_u32 s31, s31, 2228224
  v_lshlrev_b32 v22, 2, v0
  buffer_load_dword v138, v22, s[36:39], s32 offen sc1
  buffer_load_dword v137, off, s[36:39], s31 sc1
L_NW3:
  s_cmp_lg_u32 s3, 2
  s_cbranch_scc1 L_NX2
  buffer_load_dword v12, v9, s[40:43], 0 offen
  v_and_b32 v22, 28, v0
  v_cmp_eq_u32 vcc, 0, v22
  s_waitcnt vmcnt(0)
  s_nop 0
  v_cndmask_b32 v9, v21, v9, vcc
L_NX2:
  s_waitcnt vmcnt(0)
  s_branch L_QK
L_QPR:
  buffer_load_dwordx4 v[112:115], v6, s[36:39], s33 offen offset:0 sc1
  buffer_load_dwordx4 v[116:119], v6, s[36:39], s33 offen offset:1024 sc1
  buffer_load_dwordx4 v[120:123], v6, s[36:39], s33 offen offset:2048 sc1
  buffer_load_dwordx4 v[124:127], v6, s[36:39], s33 offen offset:3072 sc1
  buffer_load_dwordx4 v[128:131], v6, s[36:39], s32 offen offset:0 sc1
  buffer_load_dwordx4 v[132:135], v6, s[36:39], s32 offen offset:1024 sc1
  buffer_load_dwordx4 v[136:139], v6, s[36:39], s32 offen offset:2048 sc1
  buffer_load_dwordx4 v[140:143], v6, s[36:39], s32 offen offset:3072 sc1
  s_sub_u32 s57, s57, 1
  s_cbranch_scc0 L_QNS
  v_mov_b32 v6, v10
  s_add_u32 s33, s33, s54
  s_add_u32 s32, s32, s54
L_QNS:
  s_sleep 4
  s_sub_u32 s30, s30, 8
  s_cmp_gt_i32 s30, 0
  s_cbranch_scc1 L_QP0
  s_branch L_QPD
L_QG:
  s_mov_b64 exec, -1
  s_getreg_b32 s61, hwreg(HW_REG_XCC_ID, 0, 4)
  s_lshl_b32 s33, s28, 16
  s_lshr_b32 s32, s29, 2
  s_lshl_b32 s32, s32, 13
  s_add_u32 s33, s33, s32
  s_add_u32 s33, s33, 65536
  s_add_u32 s32, s33, 4096
  v_mov_b32 v6, v20
  v_lshrrev_b32 v7, 5, v0
  v_mul_u32_u24 v7, 288, v7
  v_and_b32 v8, 31, v0
  v_lshl_add_u32 v7, v8, 3, v7
  v_add_u32 v7, 155904, v7
  s_mov_b32 s57, 10
  s_waitcnt lgkmcnt(0)
  s_add_u32 s49, s49, 1
  s_mul_i32 s49, s49, 0x9e3779b1
  s_not_b32 s49, s49
  s_and_b32 s62, s49, 0xff
  s_bfe_u32 s63, s49, 0x80008
  s_bfe_u32 s64, s49, 0x80010
  s_lshr_b32 s65, s49, 24
  s_xor_b32 s61, s61, s62
  s_setprio 2
  v_bfe_u32 v10, v0, 2, 3
  v_lshlrev_b32 v10, 7, v10
  v_lshrrev_b32 v9, 5, v0
  v_lshl_or_b32 v10, v9, 13, v10
  v_and_b32 v9, 3, v0
  v_lshl_or_b32 v10, v9, 4, v10
  s_bitcmp1_b32 s29, 2
  s_cselect_b32 s54, -8128, 0
  s_add_u32 s54, s54, 4194304
W_19:
  ds_read_b32 v11, v3 offset:52
  s_waitcnt lgkmcnt(0)
  v_readfirstlane_b32 s31, v11
  s_cmp_ge_u32 s31, 4
  s_cbranch_scc1 W_20
  s_sleep 1
  s_sub_u32 s30, s30, 1
  s_cmp_gt_i32 s30, 0
  s_cbranch_scc1 W_19
W_20:
  buffer_load_dwordx4 v[48:51], v6, s[36:39], s33 offen offset:0 sc1
  buffer_load_dwordx4 v[52:55], v6, s[36:39], s33 offen offset:1024 sc1
  buffer_load_dwordx4 v[56:59], v6, s[36:39], s33 offen offset:2048 sc1
  buffer_load_dwordx4 v[60:63], v6, s[36:39], s33 offen offset:3072 sc1
  buffer_load_dwordx4 v[64:67], v6, s[36:39], s32 offen offset:0 sc1
  buffer_load_dwordx4 v[68:71], v6, s[36:39], s32 offen offset:1024 sc1
  buffer_load_dwordx4 v[72:75], v6, s[36:39], s32 offen offset:2048 sc1
  buffer_load_dwordx4 v[76:79], v6, s[36:39], s32 offen offset:3072 sc1
  s_sleep 12
  buffer_load_dwordx4 v[80:83], v6, s[36:39], s33 offen offset:0 sc1
  buffer_load_dwordx4 v[84:87], v6, s[36:39], s33 offen offset:1024 sc1
  buffer_load_dwordx4 v[88:91], v6, s[36:39], s33 offen offset:2048 sc1
  buffer_load_dwordx4 v[92:95], v6, s[36:39], s33 offen offset:3072 sc1
  buffer_load_dwordx4 v[96:99], v6, s[36:39], s32 offen offset:0 sc1
  buffer_load_dwordx4 v[100:103], v6, s[36:39], s32 offen offset:1024 sc1
  buffer_load_dwordx4 v[104:107], v6, s[36:39], s32 offen offset:2048 sc1
  buffer_load_dwordx4 v[108:111], v6, s[36:39], s32 offen offset:3072 sc1
  s_sleep 12
  buffer_load_dwordx4 v[112:115], v6, s[36:39], s33 offen offset:0 sc1
  buffer_load_dwordx4 v[116:119], v6, s[36:39], s33 offen offset:1024 sc1
  buffer_load_dwordx4 v[120:123], v6, s[36:39], s33 offen offset:2048 sc1
  buffer_load_dwordx4 v[124:127], v6, s[36:39], s33 offen offset:3072 sc1
  buffer_load_dwordx4 v[128:131], v6, s[36:39], s32 offen offset:0 sc1
  buffer_load_dwordx4 v[132:135], v6, s[36:39], s32 offen offset:1024 sc1
  buffer_load_dwordx4 v[136:139], v6, s[36:39], s32 offen offset:2048 sc1
  buffer_load_dwordx4 v[140:143], v6, s[36:39], s32 offen offset:3072 sc1
L_QP0:
  s_waitcnt vmcnt(22)
  v_xor_b32 v16, s61, v48
  v_xor_b32 v17, s63, v49
  v_xor_b32 v18, s64, v50
  v_xor_b32 v19, s65, v51
  v_or3_b32 v11, v17, v18, v19
  v_xor_b32 v20, s61, v52
  v_xor_b32 v21, s63, v53
  v_xor_b32 v22, s64, v54
  v_xor_b32 v23, s65, v55
  v_or3_b32 v8, v20, v16, 0
  v_or3_b32 v11, v11, v21, v22
  s_waitcnt vmcnt(20)
  v_xor_b32 v24, s61, v56
  v_xor_b32 v25, s63, v57
  v_xor_b32 v26, s64, v58
  v_xor_b32 v27, s65, v59
  v_or3_b32 v11, v11, v25, v23
  v_or3_b32 v11, v11, v26, v27
  v_xor_b32 v28, s61, v60
  v_xor_b32 v29, s63, v61
  v_xor_b32 v30, s64, v62
  v_xor_b32 v31, s65, v63
  v_or3_b32 v8, v28, v24, v8
  v_or3_b32 v11, v11, v29, v30
  s_waitcnt vmcnt(18)
  v_xor_b32 v32, s61, v64
  v_xor_b32 v33, s63, v65
  v_xor_b32 v34, s64, v66
  v_xor_b32 v35, s65, v67
  v_or3_b32 v11, v11, v33, v31
  v_or3_b32 v11, v11, v34, v35
  v_xor_b32 v36, s61, v68
  v_xor_b32 v37, s63, v69
  v_xor_b32 v38, s64, v70
  v_xor_b32 v39, s65, v71
  v_or3_b32 v8, v36, v32, v8
  v_or3_b32 v11, v11, v37, v38
  s_waitcnt vmcnt(16)
  v_xor_b32 v40, s61, v72
  v_xor_b32 v41, s63, v73
  v_xor_b32 v42, s64, v74
  v_xor_b32 v43, s65, v75
  v_or3_b32 v11, v11, v41, v39
  v_or3_b32 v11, v11, v42, v43
  v_xor_b32 v44, s61, v76
  v_xor_b32 v45, s63, v77
  v_xor_b32 v46, s64, v78
  v_xor_b32 v47, s65, v79
  v_or3_b32 v8, v44, v40, v8
  v_or3_b32 v11, v11, v45, v46
  v_and_b32 v9, 0xf0, v8
  v_or3_b32 v11, v11, v47, v9
  v_and_b32 v11, 0xff, v11
  v_cmp_ne_u32 vcc, 0, v11
  s_cbranch_vccz L_QPD
  buffer_load_dwordx4 v[48:51], v6, s[36:39], s33 offen offset:0 sc1
  buffer_load_dwordx4 v[52:55], v6, s[36:39], s33 offen offset:1024 sc1
  buffer_load_dwordx4 v[56:59], v6, s[36:39], s33 offen offset:2048 sc1
  buffer_load_dwordx4 v[60:63], v6, s[36:39], s33 offen offset:3072 sc1
  buffer_load_dwordx4 v[64:67], v6, s[36:39], s32 offen offset:0 sc1
  buffer_load_dwordx4 v[68:71], v6, s[36:39], s32 offen offset:1024 sc1
  buffer_load_dwordx4 v[72:75], v6, s[36:39], s32 offen offset:2048 sc1
  buffer_load_dwordx4 v[76:79], v6, s[36:39], s32 offen offset:3072 sc1
  s_sleep 4
L_QP1:
  s_waitcnt vmcnt(22)
  v_xor_b32 v16, s61, v80
  v_xor_b32 v17, s63, v81
  v_xor_b32 v18, s64, v82
  v_xor_b32 v19, s65, v83
  v_or3_b32 v11, v17, v18, v19
  v_xor_b32 v20, s61, v84
  v_xor_b32 v21, s63, v85
  v_xor_b32 v22, s64, v86
  v_xor_b32 v23, s65, v87
  v_or3_b32 v8, v20, v16, 0
  v_or3_b32 v11, v11, v21, v22
  s_waitcnt vmcnt(20)
  v_xor_b32 v24, s61, v88
  v_xor_b32 v25, s63, v89
  v_xor_b32 v26, s64, v90
  v_xor_b32 v27, s65, v91
  v_or3_b32 v11, v11, v25, v23
  v_or3_b32 v11, v11, v26, v27
  v_xor_b32 v28, s61, v92
  v_xor_b32 v29, s63, v93
  v_xor_b32 v30, s64, v94
  v_xor_b32 v31, s65, v95
  v_or3_b32 v8, v28, v24, v8
  v_or3_b32 v11, v11, v29, v30
  s_waitcnt vmcnt(18)
  v_xor_b32 v32, s61, v96
  v_xor_b32 v33, s63, v97
  v_xor_b32 v34, s64, v98
  v_xor_b32 v35, s65, v99
  v_or3_b32 v11, v11, v33, v31
  v_or3_b32 v11, v11, v34, v35
  v_xor_b32 v36, s61, v100
  v_xor_b32 v37, s63, v101
  v_xor_b32 v38, s64, v102
  v_xor_b32 v39, s65, v103
  v_or3_b32 v8, v36, v32, v8
  v_or3_b32 v11, v11, v37, v38
  s_waitcnt vmcnt(16)
  v_xor_b32 v40, s61, v104
  v_xor_b32 v41, s63, v105
  v_xor_b32 v42, s64, v106
  v_xor_b32 v43, s65, v107
  v_or3_b32 v11, v11, v41, v39
  v_or3_b32 v11, v11, v42, v43
  v_xor_b32 v44, s61, v108
  v_xor_b32 v45, s63, v109
  v_xor_b32 v46, s64, v110
  v_xor_b32 v47, s65, v111
  v_or3_b32 v8, v44, v40, v8
  v_or3_b32 v11, v11, v45, v46
  v_and_b32 v9, 0xf0, v8
  v_or3_b32 v11, v11, v47, v9
  v_and_b32 v11, 0xff, v11
  v_cmp_ne_u32 vcc, 0, v11
  s_cbranch_vccz L_QPD
  buffer_load_dwordx4 v[80:83], v6, s[36:39], s33 offen offset:0 sc1
  buffer_load_dwordx4 v[84:87], v6, s[36:39], s33 offen offset:1024 sc1
  buffer_load_dwordx4 v[88:91], v6, s[36:39], s33 offen offset:2048 sc1
  buffer_load_dwordx4 v[92:95], v6, s[36:39], s33 offen offset:3072 sc1
  buffer_load_dwordx4 v[96:99], v6, s[36:39], s32 offen offset:0 sc1
  buffer_load_dwordx4 v[100:103], v6, s[36:39], s32 offen offset:1024 sc1
  buffer_load_dwordx4 v[104:107], v6, s[36:39], s32 offen offset:2048 sc1
  buffer_load_dwordx4 v[108:111], v6, s[36:39], s32 offen offset:3072 sc1
  s_sleep 4
L_QP2:
  s_waitcnt vmcnt(22)
  v_xor_b32 v16, s61, v112
  v_xor_b32 v17, s63, v113
  v_xor_b32 v18, s64, v114
  v_xor_b32 v19, s65, v115
  v_or3_b32 v11, v17, v18, v19
  v_xor_b32 v20, s61, v116
  v_xor_b32 v21, s63, v117
  v_xor_b32 v22, s64, v118
  v_xor_b32 v23, s65, v119
  v_or3_b32 v8, v20, v16, 0
  v_or3_b32 v11, v11, v21, v22
  s_waitcnt vmcnt(20)
  v_xor_b32 v24, s61, v120
  v_xor_b32 v25, s63, v121
  v_xor_b32 v26, s64, v122
  v_xor_b32 v27, s65, v123
  v_or3_b32 v11, v11, v25, v23
  v_or3_b32 v11, v11, v26, v27
  v_xor_b32 v28, s61, v124
  v_xor_b32 v29, s63, v125
  v_xor_b32 v30, s64, v126
  v_xor_b32 v31, s65, v127
  v_or3_b32 v8, v28, v24, v8
  v_or3_b32 v11, v11, v29, v30
  s_waitcnt vmcnt(18)
  v_xor_b32 v32, s61, v128
  v_xor_b32 v33, s63, v129
  v_xor_b32 v34, s64, v130
  v_xor_b32 v35, s65, v131
  v_or3_b32 v11, v11, v33, v31
  v_or3_b32 v11, v11, v34, v35
  v_xor_b32 v36, s61, v132
  v_xor_b32 v37, s63, v133
  v_xor_b32 v38, s64, v134
  v_xor_b32 v39, s65, v135
  v_or3_b32 v8, v36, v32, v8
  v_or3_b32 v11, v11, v37, v38
  s_waitcnt vmcnt(16)
  v_xor_b32 v40, s61, v136
  v_xor_b32 v41, s63, v137
  v_xor_b32 v42, s64, v138
  v_xor_b32 v43, s65, v139
  v_or3_b32 v11, v11, v41, v39
  v_or3_b32 v11, v11, v42, v43
  v_xor_b32 v44, s61, v140
  v_xor_b32 v45, s63, v141
  v_xor_b32 v46, s64, v142
  v_xor_b32 v47, s65, v143
  v_or3_b32 v8, v44, v40, v8
  v_or3_b32 v11, v11, v45, v46
  v_and_b32 v9, 0xf0, v8
  v_or3_b32 v11, v11, v47, v9
  v_and_b32 v11, 0xff, v11
  v_cmp_ne_u32 vcc, 0, v11
  s_cbranch_vccnz L_QPR
L_QPD:
  v_and_b32 v8, 15, v8
  v_cmp_ne_u32 vcc, 0, v8
  v_and_b32 v16, -16, v16
  v_and_b32 v20, -16, v20
  v_and_b32 v24, -16, v24
  v_and_b32 v28, -16, v28
  v_and_b32 v32, -16, v32
  v_and_b32 v36, -16, v36
  v_and_b32 v40, -16, v40
  v_and_b32 v44, -16, v44
  s_cmp_eq_u64 vcc, 0
  s_cselect_b32 s31, 3, 1
  v_mov_b32 v8, s31
  v_pk_add_f32 v[16:17], v[16:17], v[24:25]
  v_pk_add_f32 v[32:33], v[32:33], v[40:41]
  v_pk_add_f32 v[18:19], v[18:19], v[26:27]
  v_pk_add_f32 v[34:35], v[34:35], v[42:43]
  v_pk_add_f32 v[20:21], v[20:21], v[28:29]
  v_pk_add_f32 v[36:37], v[36:37], v[44:45]
  v_pk_add_f32 v[22:23], v[22:23], v[30:31]
  v_pk_add_f32 v[38:39], v[38:39], v[46:47]
  v_pk_add_f32 v[16:17], v[16:17], v[32:33]
  v_pk_add_f32 v[18:19], v[18:19], v[34:35]
  v_pk_add_f32 v[20:21], v[20:21], v[36:37]
  v_pk_add_f32 v[22:23], v[22:23], v[38:39]
  v_cvt_pk_bf16_f32 v24, v16, v17
  v_cvt_pk_bf16_f32 v25, v18, v19
  v_cvt_pk_bf16_f32 v26, v20, v21
  v_cvt_pk_bf16_f32 v27, v22, v23
  ds_write_b64 v7, v[24:25]
  ds_write_b64 v7, v[26:27] offset:576
  ds_write_b32 v3, v8 offset:16
  s_waitcnt lgkmcnt(0)
  s_branch L_FIN
L_QK:
  v_and_b32 v22, 7, v1
  v_lshlrev_b32 v22, 1, v22
  v_xor_b32 v22, v22, v2
  v_lshlrev_b32 v22, 4, v22
  v_lshl_or_b32 v22, v1, 8, v22
  s_lshl_b32 s32, s3, 13
  v_add_u32 v22, s32, v22
  v_xor_b32 v23, 64, v22
  v_xor_b32 v24, 0x80, v22
  v_xor_b32 v25, 0xc0, v22
  v_and_b32 v26, 3, v1
  v_mul_u32_u24 v27, 288, v26
  v_lshl_add_u32 v27, v2, 4, v27
  v_add_u32 v27, 155904, v27
  v_lshlrev_b32 v26, 5, v26
  v_add_u32 v26, 157056, v26
  s_lshl_b32 s32, s3, 2
  v_add_u32 v28, s32, v26
  s_lshl_b32 s32, s3, 10
  s_add_u32 s32, s32, 147456
  v_add_u32 v29, s32, v20
W_21:
  ds_read_b32 v11, v3 offset:0
  s_waitcnt lgkmcnt(0)
  v_readfirstlane_b32 s31, v11
  s_cmp_ge_u32 s31, 144
  s_cbranch_scc1 W_22
  s_sleep 1
  s_sub_u32 s30, s30, 1
  s_cmp_gt_i32 s30, 0
  s_cbranch_scc1 W_21
W_22:
  ds_read_b128 v[64:67], v22 offset:0
  ds_read_b128 v[68:71], v23 offset:0
  ds_read_b128 v[72:75], v24 offset:0
  ds_read_b128 v[76:79], v25 offset:0
  ds_read_b128 v[80:83], v22 offset:4096
  ds_read_b128 v[84:87], v23 offset:4096
  ds_read_b128 v[88:91], v24 offset:4096
  ds_read_b128 v[92:95], v25 offset:4096
  v_lshrrev_b32 v22, 2, v0
  v_and_b32 v23, 7, v22
  v_xor_b32 v23, s3, v23
  v_lshlrev_b32 v23, 5, v23
  v_lshl_or_b32 v22, v22, 8, v23
  v_and_b32 v23, 3, v0
  v_lshl_or_b32 v22, v23, 3, v22
  v_add_u32 v22, 65536, v22
  v_add_u32 v23, 147456, v20
  s_add_u32 s57, s34, 7
  s_lshr_b32 s57, s57, 3
  s_sub_u32 s58, 0, s34
  s_and_b32 s58, s58, 7
  s_add_u32 s58, s58, 144
  s_add_u32 s32, s57, 0
  s_and_b32 s32, s32, 7
  s_lshl_b32 s33, s32, 10
  v_add_u32 v96, s33, v23
  s_lshl_b32 s33, s32, 13
  v_add_u32 v128, s33, v22
  s_add_u32 s32, s57, 1
  s_and_b32 s32, s32, 7
  s_lshl_b32 s33, s32, 10
  v_add_u32 v100, s33, v23
  s_lshl_b32 s33, s32, 13
  v_add_u32 v129, s33, v22
  s_add_u32 s32, s57, 2
  s_and_b32 s32, s32, 7
  s_lshl_b32 s33, s32, 10
  v_add_u32 v104, s33, v23
  s_lshl_b32 s33, s32, 13
  v_add_u32 v130, s33, v22
  s_add_u32 s32, s57, 3
  s_and_b32 s32, s32, 7
  s_lshl_b32 s33, s32, 10
  v_add_u32 v108, s33, v23
  s_lshl_b32 s33, s32, 13
  v_add_u32 v131, s33, v22
  s_add_u32 s32, s57, 4
  s_and_b32 s32, s32, 7
  s_lshl_b32 s33, s32, 10
  v_add_u32 v112, s33, v23
  s_lshl_b32 s33, s32, 13
  v_add_u32 v132, s33, v22
  s_add_u32 s32, s57, 5
  s_and_b32 s32, s32, 7
  s_lshl_b32 s33, s32, 10
  v_add_u32 v116, s33, v23
  s_lshl_b32 s33, s32, 13
  v_add_u32 v133, s33, v22
  s_add_u32 s32, s57, 6
  s_and_b32 s32, s32, 7
  s_lshl_b32 s33, s32, 10
  v_add_u32 v120, s33, v23
  s_lshl_b32 s33, s32, 13
  v_add_u32 v134, s33, v22
  s_add_u32 s32, s57, 7
  s_and_b32 s32, s32, 7
  s_lshl_b32 s33, s32, 10
  v_add_u32 v124, s33, v23
  s_lshl_b32 s33, s32, 13
  v_add_u32 v135, s33, v22
W_23:
  ds_read_b32 v11, v3 offset:16
  s_waitcnt lgkmcnt(0)
  v_readfirstlane_b32 s31, v11
  s_cmp_ge_u32 s31, 1
  s_cbranch_scc1 W_24
  s_sleep 1
  s_sub_u32 s30, s30, 1
  s_cmp_gt_i32 s30, 0
  s_cbranch_scc1 W_23
W_24:
  s_mov_b32 s48, s31
  s_cmp_eq_u32 s31, 3
  s_cselect_b32 s6, 5242880, 0
  s_cselect_b32 s10, 0, 5242880
  ds_read_b128 v[48:51], v27 offset:0
  ds_read_b128 v[52:55], v27 offset:64
  ds_read_b128 v[56:59], v27 offset:128
  ds_read_b128 v[60:63], v27 offset:192
  s_waitcnt lgkmcnt(3)
  v_mfma_f32_16x16x32_bf16 v[32:35], v[64:67], v[48:51], 0
  v_mfma_f32_16x16x32_bf16 v[36:39], v[80:83], v[48:51], 0
  s_waitcnt lgkmcnt(2)
  v_mfma_f32_16x16x32_bf16 v[32:35], v[68:71], v[52:55], v[32:35]
  v_mfma_f32_16x16x32_bf16 v[36:39], v[84:87], v[52:55], v[36:39]
  s_waitcnt lgkmcnt(1)
  v_mfma_f32_16x16x32_bf16 v[32:35], v[72:75], v[56:59], v[32:35]
  v_mfma_f32_16x16x32_bf16 v[36:39], v[88:91], v[56:59], v[36:39]
  s_waitcnt lgkmcnt(0)
  v_mfma_f32_16x16x32_bf16 v[32:35], v[76:79], v[60:63], v[32:35]
  v_mfma_f32_16x16x32_bf16 v[36:39], v[92:95], v[60:63], v[36:39]
  s_nop 6
  v_cvt_pk_bf16_f32 v40, v32, v33
  v_cvt_pk_bf16_f32 v41, v34, v35
  v_cvt_pk_bf16_f32 v42, v36, v37
  v_cvt_pk_bf16_f32 v43, v38, v39
  v_lshlrev_b32 v32, 16, v40
  v_and_b32 v33, 0xffff0000, v40
  v_lshlrev_b32 v34, 16, v41
  v_and_b32 v35, 0xffff0000, v41
  v_lshlrev_b32 v36, 16, v42
  v_and_b32 v37, 0xffff0000, v42
  v_lshlrev_b32 v38, 16, v43
  v_and_b32 v39, 0xffff0000, v43
  v_mul_f32 v32, 0x3db504f3, v32
  v_mul_f32 v33, 0x3db504f3, v33
  v_mul_f32 v34, 0x3db504f3, v34
  v_mul_f32 v35, 0x3db504f3, v35
  v_mul_f32 v36, 0x3db504f3, v36
  v_mul_f32 v37, 0x3db504f3, v37
  v_mul_f32 v38, 0x3db504f3, v38
  v_mul_f32 v39, 0x3db504f3, v39
  v_cvt_pk_bf16_f32 v40, v32, v33
  v_cvt_pk_bf16_f32 v41, v34, v35
  v_cvt_pk_bf16_f32 v42, v36, v37
  v_cvt_pk_bf16_f32 v43, v38, v39
  v_lshlrev_b32 v32, 16, v40
  v_and_b32 v33, 0xffff0000, v40
  v_lshlrev_b32 v34, 16, v41
  v_and_b32 v35, 0xffff0000, v41
  v_lshlrev_b32 v36, 16, v42
  v_and_b32 v37, 0xffff0000, v42
  v_lshlrev_b32 v38, 16, v43
  v_and_b32 v39, 0xffff0000, v43
  v_max3_f32 v44, v32, v33, v34
  v_max3_f32 v45, v35, v36, v37
  v_max3_f32 v44, v44, v38, v39
  v_max_f32 v44, v44, v45
  v_mov_b32 v45, v44
  s_nop 1
  v_permlane16_swap_b32 v44, v45
  v_max_f32 v44, v44, v45
  v_mov_b32 v45, v44
  s_nop 1
  v_permlane32_swap_b32 v44, v45
  v_max_f32 v44, v44, v45
  s_mov_b64 exec, 15
  ds_write_b32 v28, v44
  s_mov_b64 exec, 1
  ds_add_u32 v3, v4 offset:20
  s_mov_b64 exec, -1
  s_mov_b32 s32, 0x3fb8aa3b
W_25:
  ds_read_b32 v11, v3 offset:20
  s_waitcnt lgkmcnt(0)
  v_readfirstlane_b32 s31, v11
  s_cmp_ge_u32 s31, 8
  s_cbranch_scc1 W_26
  s_sub_u32 s30, s30, 1
  s_cmp_gt_i32 s30, 0
  s_cbranch_scc1 W_25
W_26:
  ds_read_b128 v[48:51], v26
  ds_read_b128 v[52:55], v26 offset:16
  s_waitcnt lgkmcnt(0)
  v_max3_f32 v44, v48, v49, v50
  v_max3_f32 v45, v51, v52, v53
  v_max3_f32 v44, v44, v54, v55
  v_max_f32 v44, v44, v45
  v_mul_f32 v44, s32, v44
  v_fma_f32 v32, v32, s32, -v44
  v_fma_f32 v33, v33, s32, -v44
  v_fma_f32 v34, v34, s32, -v44
  v_fma_f32 v35, v35, s32, -v44
  v_fma_f32 v36, v36, s32, -v44
  v_fma_f32 v37, v37, s32, -v44
  v_fma_f32 v38, v38, s32, -v44
  v_fma_f32 v39, v39, s32, -v44
  v_exp_f32 v32, v32
  v_exp_f32 v33, v33
  v_exp_f32 v34, v34
  v_exp_f32 v35, v35
  v_exp_f32 v36, v36
  v_exp_f32 v37, v37
  v_exp_f32 v38, v38
  v_exp_f32 v39, v39
  v_cvt_pk_bf16_f32 v40, v32, v33
  v_cvt_pk_bf16_f32 v41, v34, v35
  v_cvt_pk_bf16_f32 v42, v36, v37
  v_cvt_pk_bf16_f32 v43, v38, v39
  ds_write_b128 v29, v[40:43]
  v_add_f32 v46, v32, v33
  v_add_f32 v45, v34, v35
  v_add_f32 v47, v36, v37
  v_add_f32 v46, v46, v45
  v_add_f32 v45, v38, v39
  v_add_f32 v47, v47, v45
  v_add_f32 v46, v46, v47
  v_mov_b32 v45, v46
  s_nop 1
  v_permlane16_swap_b32 v46, v45
  v_add_f32 v46, v46, v45
  v_mov_b32 v45, v46
  s_nop 1
  v_permlane32_swap_b32 v46, v45
  v_add_f32 v46, v46, v45
  s_mov_b64 exec, 15
  ds_write_b32 v28, v46 offset:128
  s_mov_b64 exec, 1
  ds_add_u32 v3, v4 offset:24
  s_mov_b64 exec, -1
  s_waitcnt vmcnt(0)
W_27:
  ds_read_b32 v11, v3 offset:24
  s_waitcnt lgkmcnt(0)
  v_readfirstlane_b32 s31, v11
  s_cmp_ge_u32 s31, 8
  s_cbranch_scc1 W_28
  s_sub_u32 s30, s30, 1
  s_cmp_gt_i32 s30, 0
  s_cbranch_scc1 W_27
W_28:
  ds_read_b128 v[96:99], v96
  ds_read_b128 v[100:103], v100
  ds_read_b128 v[104:107], v104
  ds_read_b128 v[108:111], v108
  ds_read_b128 v[112:115], v112
  ds_read_b128 v[116:119], v116
  ds_read_b128 v[120:123], v120
  ds_read_b128 v[124:127], v124
  s_cmp_lg_u32 s3, 0
  s_cbranch_scc1 L_PV
  ds_read_b128 v[48:51], v26 offset:128
  ds_read_b128 v[52:55], v26 offset:144
  s_waitcnt lgkmcnt(0)
  v_add_f32 v48, v48, v49
  v_add_f32 v50, v50, v51
  v_add_f32 v52, v52, v53
  v_add_f32 v54, v54, v55
  v_add_f32 v48, v48, v50
  v_add_f32 v52, v52, v54
  v_add_f32 v48, v48, v52
  v_log_f32 v48, v48
  v_mov_b32 v46, v15
  v_mov_b32 v47, v15
  v_add_f32 v45, v48, v44
  buffer_store_dwordx4 v[44:47], v8, s[4:7], s59 offen
  buffer_store_dwordx4 v[44:47], v8, s[8:11], s59 offen sc1
L_PV:
  s_add_u32 s32, s58, 32
W_29:
  ds_read_b32 v11, v3 offset:0
  s_waitcnt lgkmcnt(0)
  v_readfirstlane_b32 s31, v11
  s_cmp_ge_u32 s31, s32
  s_cbranch_scc1 W_30
  s_sleep 1
  s_sub_u32 s30, s30, 1
  s_cmp_gt_i32 s30, 0
  s_cbranch_scc1 W_29
W_30:
  ds_read_b64_tr_b16 v[48:49], v128
  ds_read_b64_tr_b16 v[50:51], v128 offset:4096
  ds_read_b64_tr_b16 v[52:53], v129
  ds_read_b64_tr_b16 v[54:55], v129 offset:4096
  ds_read_b64_tr_b16 v[56:57], v130
  ds_read_b64_tr_b16 v[58:59], v130 offset:4096
  ds_read_b64_tr_b16 v[60:61], v131
  ds_read_b64_tr_b16 v[62:63], v131 offset:4096
  s_waitcnt lgkmcnt(6)
  v_mfma_f32_16x16x32_bf16 v[32:35], v[48:51], v[96:99], 0
  s_waitcnt lgkmcnt(4)
  v_mfma_f32_16x16x32_bf16 v[32:35], v[52:55], v[100:103], v[32:35]
  s_waitcnt lgkmcnt(2)
  v_mfma_f32_16x16x32_bf16 v[32:35], v[56:59], v[104:107], v[32:35]
  s_waitcnt lgkmcnt(0)
  v_mfma_f32_16x16x32_bf16 v[32:35], v[60:63], v[108:111], v[32:35]
  s_mul_i32 s31, s3, 160
  s_add_u32 s31, s31, 157312
  v_lshl_add_u32 v19, v0, 1, s31
  v_lshlrev_b32 v22, 2, v0
  s_lshl3_add_u32 s12, s28, s3
  s_lshl_b32 s12, s12, 13
  s_and_b32 s31, s29, 24
  s_lshl_b32 s31, s31, 8
  s_add_u32 s12, s12, s31
  s_add_u32 s12, s12, 65536
  s_add_u32 s13, s12, 4096
  s_add_u32 s14, s12, 8192
  s_add_u32 s15, s12, 12288
  s_and_b32 s31, s29, 7
  s_lshl_b32 s31, s31, 11
  s_add_u32 s31, s31, s12
  s_lshl_b32 s16, s56, 9
  s_add_u32 s16, s16, 2228224
  s_lshl_b32 s31, s3, 6
  v_and_b32 v29, 3, v0
  v_lshl_add_u32 v29, v29, 4, s31
  v_lshlrev_b32 v136, 3, v0
  v_add_u32 v136, 158976, v136
  s_mov_b32 s17, 0x3f803f80
  s_movk_i32 s19, 0xff
  s_cmp_ge_u32 s3, 2
  s_cbranch_scc1 L_RD
  v_lshlrev_b32 v23, 4, v1
  s_lshl_b32 s31, s3, 12
  s_add_u32 s31, s31, s53
  v_and_b32 v137, 7, v1
  v_mul_u32_u24 v137, 160, v137
  v_lshl_add_u32 v137, v2, 4, v137
  v_add_u32 v137, 157312, v137
  v_mov_b32 v24, 159488
  v_cmp_gt_u32 vcc, 8, v1
  s_nop 1
  v_cndmask_b32 v138, v137, v24, vcc
  v_cndmask_b32 v137, v24, v137, vcc
  v_mov_b32 v26, 0
  v_mov_b32 v27, 0
  v_lshl_add_u32 v24, v1, 3, v24
  ds_write_b64 v24, v[26:27]
  v_add_u32 v142, 131072, v10
  v_xor_b32 v143, 32, v142
L_RD:
  s_add_u32 s32, s58, 56
W_31:
  ds_read_b32 v11, v3 offset:0
  s_waitcnt lgkmcnt(0)
  v_readfirstlane_b32 s31, v11
  s_cmp_ge_u32 s31, s32
  s_cbranch_scc1 W_32
  s_sleep 1
  s_sub_u32 s30, s30, 1
  s_cmp_gt_i32 s30, 0
  s_cbranch_scc1 W_31
W_32:
  ds_read_b64_tr_b16 v[48:49], v132
  ds_read_b64_tr_b16 v[50:51], v132 offset:4096
  ds_read_b64_tr_b16 v[52:53], v133
  ds_read_b64_tr_b16 v[54:55], v133 offset:4096
  ds_read_b64_tr_b16 v[56:57], v134
  ds_read_b64_tr_b16 v[58:59], v134 offset:4096
  s_waitcnt lgkmcnt(4)
  v_mfma_f32_16x16x32_bf16 v[32:35], v[48:51], v[112:115], v[32:35]
  s_waitcnt lgkmcnt(2)
  v_mfma_f32_16x16x32_bf16 v[32:35], v[52:55], v[116:119], v[32:35]
  s_waitcnt lgkmcnt(0)
  v_mfma_f32_16x16x32_bf16 v[32:35], v[56:59], v[120:123], v[32:35]
  s_cmp_ge_u32 s3, 2
  s_cbranch_scc1 L_NLS
  buffer_load_dwordx3 v[24:26], v23, s[36:39], s55 offen sc1
  buffer_load_dwordx3 v[40:42], v23, s[36:39], s55 offen offset:256 sc1
L_NLS:
  s_setprio 3
  s_barrier
  ds_read_b64_tr_b16 v[48:49], v135
  ds_read_b64_tr_b16 v[50:51], v135 offset:4096
  s_waitcnt lgkmcnt(0)
  v_mfma_f32_16x16x32_bf16 v[32:35], v[48:51], v[124:127], v[32:35]
  s_nop 7
  v_cvt_pk_bf16_f32 v36, v32, v33
  v_cvt_pk_bf16_f32 v37, v34, v35
  v_min_u32 v36, -2, v36
  v_min_u32 v37, -2, v37
  buffer_store_dwordx2 v[36:37], v6, s[4:7], s50 offen
  buffer_store_dwordx2 v[36:37], v6, s[8:11], s50 offen sc1
  s_setprio 1
  s_cbranch_scc1 L_NO
W_33:
  ds_read_b32 v11, v3 offset:0
  s_waitcnt lgkmcnt(0)
  v_readfirstlane_b32 s31, v11
  s_cmp_ge_u32 s31, 300
  s_cbranch_scc1 W_34
  s_sub_u32 s30, s30, 1
  s_cmp_gt_i32 s30, 0
  s_cbranch_scc1 W_33
W_34:
  buffer_load_dwordx4 v[96:99], v9, s[36:39], s53 offen offset:0 sc1
  buffer_load_dwordx4 v[112:115], v9, s[36:39], s54 offen offset:0 sc1
  buffer_load_dwordx4 v[100:103], v9, s[36:39], s53 offen offset:1024 sc1
  buffer_load_dwordx4 v[116:119], v9, s[36:39], s54 offen offset:1024 sc1
  buffer_load_dwordx4 v[104:107], v9, s[36:39], s53 offen offset:2048 sc1
  buffer_load_dwordx4 v[120:123], v9, s[36:39], s54 offen offset:2048 sc1
  buffer_load_dwordx4 v[108:111], v9, s[36:39], s53 offen offset:3072 sc1
  buffer_load_dwordx4 v[124:127], v9, s[36:39], s54 offen offset:3072 sc1
  ds_read_b64_tr_b16 v[64:65], v142 offset:0
  ds_read_b64_tr_b16 v[66:67], v142 offset:512
  ds_read_b64_tr_b16 v[68:69], v142 offset:4096
  ds_read_b64_tr_b16 v[70:71], v142 offset:4608
  ds_read_b64_tr_b16 v[72:73], v142 offset:8192
  ds_read_b64_tr_b16 v[74:75], v142 offset:8704
  ds_read_b64_tr_b16 v[76:77], v142 offset:12288
  ds_read_b64_tr_b16 v[78:79], v142 offset:12800
  ds_read_b64_tr_b16 v[80:81], v143 offset:0
  ds_read_b64_tr_b16 v[82:83], v143 offset:512
  ds_read_b64_tr_b16 v[84:85], v143 offset:4096
  ds_read_b64_tr_b16 v[86:87], v143 offset:4608
  ds_read_b64_tr_b16 v[88:89], v143 offset:8192
  ds_read_b64_tr_b16 v[90:91], v143 offset:8704
  ds_read_b64_tr_b16 v[92:93], v143 offset:12288
  ds_read_b64_tr_b16 v[94:95], v143 offset:12800
  s_waitcnt vmcnt(10)
L_LP:
  v_cmp_ne_u32 vcc, s49, v26
  v_cmp_ne_u32 s[60:61], s49, v42
  v_max_f32 v28, v25, v41
  s_or_b64 vcc, vcc, s[60:61]
  s_cbranch_scc1 L_LPR
L_LPD:
  v_max_f32_dpp v28, v28, v28 row_ror:8 row_mask:0xf bank_mask:0xf
  v_sub_f32 v30, v25, v28
  v_sub_f32 v31, v41, v28
  v_exp_f32 v30, v30
  v_exp_f32 v31, v31
  v_sub_f32 v24, v24, v28
  v_sub_f32 v40, v40, v28
  v_add_f32 v28, v30, v31
  v_exp_f32 v30, v24
  v_exp_f32 v31, v40
  v_add_f32_dpp v28, v28, v28 row_ror:8 row_mask:0xf bank_mask:0xf
  v_rcp_f32 v28, v28
  s_waitcnt lgkmcnt(0)
  v_mul_f32 v30, v30, v28
  v_mul_f32 v31, v31, v28
L_OP0:
  s_waitcnt vmcnt(6)
  v_mfma_f32_16x16x32_bf16 v[32:35], v[64:67], v[96:99], 0
  v_max_u32 v11, v96, v97
  v_mfma_f32_16x16x32_bf16 v[36:39], v[64:67], v[112:115], 0
  v_max3_u32 v11, v11, v112, v113
  v_mfma_f32_16x16x32_bf16 v[40:43], v[80:83], v[96:99], 0
  v_max3_u32 v11, v11, v98, v99
  v_mfma_f32_16x16x32_bf16 v[44:47], v[80:83], v[112:115], 0
  v_max3_u32 v11, v11, v114, v115
  s_waitcnt vmcnt(4)
  v_mfma_f32_16x16x32_bf16 v[32:35], v[68:71], v[100:103], v[32:35]
  v_max3_u32 v11, v11, v100, v101
  v_mfma_f32_16x16x32_bf16 v[36:39], v[68:71], v[116:119], v[36:39]
  v_max3_u32 v11, v11, v116, v117
  v_mfma_f32_16x16x32_bf16 v[40:43], v[84:87], v[100:103], v[40:43]
  v_max3_u32 v11, v11, v102, v103
  v_mfma_f32_16x16x32_bf16 v[44:47], v[84:87], v[116:119], v[44:47]
  v_max3_u32 v11, v11, v118, v119
  s_waitcnt vmcnt(2)
  v_mfma_f32_16x16x32_bf16 v[32:35], v[72:75], v[104:107], v[32:35]
  v_max3_u32 v11, v11, v104, v105
  v_mfma_f32_16x16x32_bf16 v[36:39], v[72:75], v[120:123], v[36:39]
  v_max3_u32 v11, v11, v120, v121
  v_mfma_f32_16x16x32_bf16 v[40:43], v[88:91], v[104:107], v[40:43]
  v_max3_u32 v11, v11, v106, v107
  v_mfma_f32_16x16x32_bf16 v[44:47], v[88:91], v[120:123], v[44:47]
  v_max3_u32 v11, v11, v122, v123
  s_waitcnt vmcnt(0)
  v_mfma_f32_16x16x32_bf16 v[32:35], v[76:79], v[108:111], v[32:35]
  v_max3_u32 v11, v11, v108, v109
  v_mfma_f32_16x16x32_bf16 v[36:39], v[76:79], v[124:127], v[36:39]
  v_max3_u32 v11, v11, v124, v125
  v_mfma_f32_16x16x32_bf16 v[40:43], v[92:95], v[108:111], v[40:43]
  v_max3_u32 v11, v11, v110, v111
  v_mfma_f32_16x16x32_bf16 v[44:47], v[92:95], v[124:127], v[44:47]
  v_max3_u32 v11, v11, v126, v127
  v_cmp_eq_u32 vcc, -1, v11
  s_cbranch_vccnz L_OPR
L_OPD:
  s_mov_b64 exec, 1
  ds_add_u32 v3, v4 offset:28
  s_mov_b64 exec, -1
  v_pk_mul_f32 v[32:33], v[32:33], v[30:31] op_sel_hi:[1,0]
  v_pk_mul_f32 v[34:35], v[34:35], v[30:31] op_sel_hi:[1,0]
  v_pk_fma_f32 v[32:33], v[36:37], v[30:31], v[32:33] op_sel:[0,1,0] op_sel_hi:[1,1,1]
  v_pk_fma_f32 v[34:35], v[38:39], v[30:31], v[34:35] op_sel:[0,1,0] op_sel_hi:[1,1,1]
  v_pk_mul_f32 v[40:41], v[40:41], v[30:31] op_sel_hi:[1,0]
  v_pk_mul_f32 v[42:43], v[42:43], v[30:31] op_sel_hi:[1,0]
  v_pk_fma_f32 v[40:41], v[44:45], v[30:31], v[40:41] op_sel:[0,1,0] op_sel_hi:[1,1,1]
  v_pk_fma_f32 v[42:43], v[46:47], v[30:31], v[42:43] op_sel:[0,1,0] op_sel_hi:[1,1,1]
  v_add_f32_dpp v48, v32, v32 row_ror:8 row_mask:0xf bank_mask:0x3
  v_add_f32_dpp v49, v33, v33 row_ror:8 row_mask:0xf bank_mask:0x3
  v_add_f32_dpp v50, v34, v34 row_ror:8 row_mask:0xf bank_mask:0x3
  v_add_f32_dpp v51, v35, v35 row_ror:8 row_mask:0xf bank_mask:0x3
  v_add_f32_dpp v48, v40, v40 row_ror:8 row_mask:0xf bank_mask:0xc
  v_add_f32_dpp v49, v41, v41 row_ror:8 row_mask:0xf bank_mask:0xc
  v_add_f32_dpp v50, v42, v42 row_ror:8 row_mask:0xf bank_mask:0xc
  v_add_f32_dpp v51, v43, v43 row_ror:8 row_mask:0xf bank_mask:0xc
  v_perm_b32 v48, v48, v15, s66
  v_perm_b32 v49, v49, v15, s67
  v_perm_b32 v50, v50, v15, s68
  v_perm_b32 v51, v51, v15, s69
  buffer_store_dwordx4 v[48:51], v7, s[36:39], s51 offen sc1
  s_sleep 13
  s_mov_b64 exec, 1
  ds_add_u32 v3, v4 offset:32
  s_mov_b64 exec, -1
  s_cmp_eq_u32 s35, 1
  s_cbranch_scc1 L_FIN
  s_setprio 0
  v_add_u32 v142, 16384, v10
  v_xor_b32 v143, 32, v142
W_35:
  ds_read_b32 v11, v3 offset:0
  s_waitcnt lgkmcnt(0)
  v_readfirstlane_b32 s31, v11
  s_cmp_ge_u32 s31, 320
  s_cbranch_scc1 W_36
  s_sleep 1
  s_sub_u32 s30, s30, 1
  s_cmp_gt_i32 s30, 0
  s_cbranch_scc1 W_35
W_36:
  ds_read_b64_tr_b16 v[64:65], v142 offset:0
  ds_read_b64_tr_b16 v[66:67], v142 offset:512
  ds_read_b64_tr_b16 v[68:69], v142 offset:4096
  ds_read_b64_tr_b16 v[70:71], v142 offset:4608
  ds_read_b64_tr_b16 v[72:73], v143 offset:0
  ds_read_b64_tr_b16 v[74:75], v143 offset:512
  ds_read_b64_tr_b16 v[76:77], v143 offset:4096
  ds_read_b64_tr_b16 v[78:79], v143 offset:4608
  s_branch L_GW
L_OPR:
  buffer_load_dwordx4 v[96:99], v9, s[36:39], s53 offen offset:0 sc1
  buffer_load_dwordx4 v[112:115], v9, s[36:39], s54 offen offset:0 sc1
  buffer_load_dwordx4 v[100:103], v9, s[36:39], s53 offen offset:1024 sc1
  buffer_load_dwordx4 v[116:119], v9, s[36:39], s54 offen offset:1024 sc1
  buffer_load_dwordx4 v[104:107], v9, s[36:39], s53 offen offset:2048 sc1
  buffer_load_dwordx4 v[120:123], v9, s[36:39], s54 offen offset:2048 sc1
  buffer_load_dwordx4 v[108:111], v9, s[36:39], s53 offen offset:3072 sc1
  buffer_load_dwordx4 v[124:127], v9, s[36:39], s54 offen offset:3072 sc1
  s_sub_u32 s30, s30, 8
  s_cmp_gt_i32 s30, 0
  s_cbranch_scc1 L_OP0
  s_branch L_OPD
L_LPR:
  s_sleep 2
  buffer_load_dwordx3 v[24:26], v23, s[36:39], s55 offen sc1
  buffer_load_dwordx3 v[40:42], v23, s[36:39], s55 offen offset:256 sc1
  buffer_load_dwordx4 v[96:99], v9, s[36:39], s53 offen offset:0 sc1
  buffer_load_dwordx4 v[112:115], v9, s[36:39], s54 offen offset:0 sc1
  buffer_load_dwordx4 v[100:103], v9, s[36:39], s53 offen offset:1024 sc1
  buffer_load_dwordx4 v[116:119], v9, s[36:39], s54 offen offset:1024 sc1
  buffer_load_dwordx4 v[104:107], v9, s[36:39], s53 offen offset:2048 sc1
  buffer_load_dwordx4 v[120:123], v9, s[36:39], s54 offen offset:2048 sc1
  buffer_load_dwordx4 v[108:111], v9, s[36:39], s53 offen offset:3072 sc1
  buffer_load_dwordx4 v[124:127], v9, s[36:39], s54 offen offset:3072 sc1
  s_waitcnt vmcnt(8)
  s_sub_u32 s30, s30, 8
  s_cmp_gt_i32 s30, 0
  s_cbranch_scc1 L_LP
  s_branch L_LPD
L_NO:
  s_setprio 0
  s_cmp_eq_u32 s3, 2
  s_cbranch_scc1 L_RED
  s_cmp_eq_u32 s35, 1
  s_cbranch_scc1 L_FIN
  s_cmp_ge_u32 s3, 4
  s_cbranch_scc1 L_GU
  s_lshl_b32 s32, s56, 11
  s_add_u32 s32, s32, 1638400
W_37:
  ds_read_b32 v11, v3 offset:40
  s_waitcnt lgkmcnt(0)
  v_readfirstlane_b32 s31, v11
  s_cmp_ge_u32 s31, 4
  s_cbranch_scc1 W_38
  s_sleep 1
  s_sub_u32 s30, s30, 1
  s_cmp_gt_i32 s30, 0
  s_cbranch_scc1 W_37
W_38:
P_39:
  buffer_load_dword v52, v22, s[36:39], s32 offen offset:0 sc1
  buffer_load_dword v53, v22, s[36:39], s32 offen offset:256 sc1
  buffer_load_dword v54, v22, s[36:39], s32 offen offset:512 sc1
  buffer_load_dword v55, v22, s[36:39], s32 offen offset:768 sc1
  buffer_load_dword v56, v22, s[36:39], s32 offen offset:1024 sc1
  buffer_load_dword v57, v22, s[36:39], s32 offen offset:1280 sc1
  buffer_load_dword v58, v22, s[36:39], s32 offen offset:1536 sc1
  buffer_load_dword v59, v22, s[36:39], s32 offen offset:1792 sc1
P_41:
  s_waitcnt vmcnt(0)
  v_xor_b32 v52, v17, v52
  v_xor_b32 v53, v17, v53
  v_xor_b32 v54, v17, v54
  v_xor_b32 v55, v17, v55
  v_xor_b32 v56, v17, v56
  v_xor_b32 v57, v17, v57
  v_xor_b32 v58, v17, v58
  v_xor_b32 v59, v17, v59
  v_or3_b32 v11, v52, v53, v54
  v_or3_b32 v11, v11, v55, v56
  v_or3_b32 v11, v11, v57, v58
  v_or_b32 v11, v11, v59
  v_and_b32 v11, 0xff, v11
  v_cmp_ne_u32 vcc, 0, v11
  s_cbranch_vccz P_40
  s_sleep 3
  s_sub_u32 s30, s30, 8
  s_cmp_gt_i32 s30, 0
  s_cbranch_scc1 P_39
P_40:
  v_add_f32 v52, v52, v54
  v_add_f32 v53, v53, v55
  v_add_f32 v56, v56, v58
  v_add_f32 v57, v57, v59
  v_add_f32 v52, v52, v56
  v_add_f32 v53, v53, v57
  ds_write_b64 v136, v[52:53]
  s_mov_b64 exec, 1
  ds_add_u32 v3, v4 offset:56
  s_mov_b64 exec, -1
  s_branch L_GW
L_APR:
  s_sleep 1
  buffer_load_dwordx4 v[64:67], v7, s[36:39], s51 offen sc1
  buffer_load_dwordx4 v[68:71], v7, s[36:39], s51 offen offset:256 sc1
  s_sub_u32 s30, s30, 8
  s_cmp_gt_i32 s30, 0
  s_cbranch_scc1 L_AP0
  s_branch L_APD
L_RED:
  v_and_b32 v13, 0xffff0000, v12
  v_lshlrev_b32 v12, 16, v12
  v_cmp_gt_u32 vcc, 48, v0
  v_mov_b32 v60, v15
  s_nop 0
  v_cndmask_b32 v60, 0, v60, vcc
  v_bfe_u32 v61, v60, 8, 8
  v_bfe_u32 v62, v60, 16, 8
  v_lshrrev_b32 v63, 24, v60
  v_and_b32 v60, 0xff, v60
  v_cmp_gt_u32 vcc, 8, v1
  v_lshlrev_b32 v140, 4, v2
  v_lshl_or_b32 v139, v1, 10, v140
  v_cndmask_b32 v139, v21, v139, vcc
  s_and_b32 s31, s29, 6
  s_lshl_b32 s32, s31, 3
  v_lshl_add_u32 v140, v1, 6, s32
  v_cndmask_b32 v140, v21, v140, vcc
  v_lshrrev_b32 v141, 2, v1
  v_cmp_eq_u32 vcc, v141, v2
  s_nop 1
  v_cndmask_b32 v140, v21, v140, vcc
  s_lshl_b32 s18, s31, 7
  s_and_b32 s31, s56, 7
  s_lshl_b32 s31, s31, 13
  s_add_u32 s18, s18, s31
  s_add_u32 s18, s18, 1572864
  v_mov_b32 v88, s17
  v_mov_b32 v89, s17
  v_mov_b32 v90, s17
  v_mov_b32 v91, s17
  s_mov_b32 s20, 0xaaaaaaaa
  s_mov_b32 s21, 0xaaaaaaaa
  s_mov_b32 s22, 0xcccccccc
  s_mov_b32 s23, 0xcccccccc
  s_setprio 2
W_42:
  ds_read_b32 v11, v3 offset:32
  s_waitcnt lgkmcnt(0)
  v_readfirstlane_b32 s31, v11
  s_cmp_ge_u32 s31, 2
  s_cbranch_scc1 W_43
  s_sleep 1
  s_sub_u32 s30, s30, 1
  s_cmp_gt_i32 s30, 0
  s_cbranch_scc1 W_42
W_43:
  buffer_load_dwordx4 v[64:67], v7, s[36:39], s51 offen sc1
  buffer_load_dwordx4 v[68:71], v7, s[36:39], s51 offen offset:256 sc1
L_AP0:
  s_waitcnt vmcnt(1)
  v_xor_b32 v64, s62, v64
  v_xor_b32 v65, s63, v65
  v_xor_b32 v66, s64, v66
  v_xor_b32 v67, s65, v67
  v_or3_b32 v11, v64, v65, v66
  s_waitcnt vmcnt(0)
  v_xor_b32 v68, s62, v68
  v_xor_b32 v69, s63, v69
  v_xor_b32 v70, s64, v70
  v_xor_b32 v71, s65, v71
  v_add_f32 v40, v64, v68
  v_add_f32 v42, v66, v70
  v_add_f32 v41, v65, v69
  v_add_f32 v43, v67, v71
  v_permlane32_swap_b32 v40, v42
  v_or3_b32 v11, v11, v67, v68
  v_permlane32_swap_b32 v41, v43
  v_add_f32 v40, v40, v42
  v_add_f32 v41, v41, v43
  v_or3_b32 v11, v11, v69, v70
  v_or_b32 v11, v11, v71
  v_permlane16_swap_b32 v40, v41
  v_add_f32 v40, v40, v41
  v_and_b32 v11, 0xff, v11
  v_cmp_ne_u32 vcc, 0, v11
  v_add_f32_dpp v40, v40, v40 row_ror:4 row_mask:0xf bank_mask:0xf
  s_nop 0
  s_cbranch_vccnz L_APR
L_APD:
  s_mov_b64 exec, 1
  ds_add_u32 v3, v4 offset:60
  s_mov_b64 exec, -1
  v_add_f32_dpp v41, v40, v40 row_ror:8 row_mask:0xf bank_mask:0xf
  v_add_f32_dpp v40, v40, v40 row_ror:8 row_mask:0xf bank_mask:0xf
  s_nop 1
  v_permlane16_swap_b32 v40, v41
  v_cvt_pk_bf16_f32 v40, v40, v41
  v_and_b32 v41, 0xffff0000, v40
  v_lshlrev_b32 v40, 16, v40
  v_add_f32 v41, v41, v13
  v_add_f32 v40, v40, v12
  v_cvt_pk_bf16_f32 v40, v40, v41
  v_min_u32 v44, -2, v40
  v_min_u32 v45, -2, v40
  v_and_b32 v13, 0xffff0000, v40
  v_lshlrev_b32 v12, 16, v40
  v_permlane32_swap_b32 v44, v45
  s_nop 1
  v_mov_b32_dpp v46, v44 quad_perm:[1,1,3,3] row_mask:0xf bank_mask:0xf
  v_mov_b32_dpp v47, v45 quad_perm:[1,1,3,3] row_mask:0xf bank_mask:0xf
  buffer_store_dwordx4 v[44:47], v18, s[36:39], s59 offen sc1
  s_cmp_lg_u32 s2, 0
  s_cbranch_scc1 L_NE
  s_mov_b64 exec, 1
  buffer_store_dword v16, off, s[36:39], 0 offset:0 sc1
  s_mov_b64 exec, -1
L_NE:
  s_sleep 19
  s_cmp_eq_u32 s35, 1
  s_cbranch_scc1 L_PHC
  s_mov_b64 exec, 1
  ds_add_u32 v3, v4 offset:36
  s_mov_b64 exec, -1
  s_bitcmp1_b32 s29, 0
  s_cbranch_scc1 L_GW
  s_sleep 1
  buffer_load_dwordx4 v[96:99], v139, s[36:39], s18 offen offset:0 sc1
  buffer_load_dwordx4 v[100:103], v139, s[36:39], s18 offen offset:64 sc1
  buffer_load_dwordx4 v[104:107], v139, s[36:39], s18 offen offset:128 sc1
  buffer_load_dwordx4 v[108:111], v139, s[36:39], s18 offen offset:192 sc1
L_SP0:
  s_waitcnt vmcnt(3)
  v_mfma_f32_16x16x32_bf16 v[40:43], v[88:91], v[96:99], 0
  v_mfma_f32_16x16x32_bf16 v[44:47], v[96:99], v[96:99], 0
  v_max3_u32 v11, v96, v97, v98
  v_max_u32 v11, v11, v99
  s_waitcnt vmcnt(2)
  v_mfma_f32_16x16x32_bf16 v[40:43], v[88:91], v[100:103], v[40:43]
  v_mfma_f32_16x16x32_bf16 v[44:47], v[100:103], v[100:103], v[44:47]
  v_max3_u32 v11, v11, v100, v101
  v_max3_u32 v11, v11, v102, v103
  s_waitcnt vmcnt(1)
  v_mfma_f32_16x16x32_bf16 v[40:43], v[88:91], v[104:107], v[40:43]
  v_mfma_f32_16x16x32_bf16 v[44:47], v[104:107], v[104:107], v[44:47]
  v_max3_u32 v11, v11, v104, v105
  v_max3_u32 v11, v11, v106, v107
  s_waitcnt vmcnt(0)
  v_mfma_f32_16x16x32_bf16 v[40:43], v[88:91], v[108:111], v[40:43]
  v_mfma_f32_16x16x32_bf16 v[44:47], v[108:111], v[108:111], v[44:47]
  v_max3_u32 v11, v11, v108, v109
  v_max3_u32 v11, v11, v110, v111
  v_cmp_eq_u32 vcc, -1, v11
  s_cbranch_vccnz L_SPR
L_SPD:
  s_nop 2
  v_mov_b32 v42, v15
  v_mov_b32 v43, v15
  v_cndmask_b32 v44, v44, v45, s[20:21]
  v_cndmask_b32 v46, v46, v47, s[20:21]
  v_cndmask_b32 v41, v44, v46, s[22:23]
  buffer_store_dwordx4 v[40:43], v140, s[4:7], s16 offen
  buffer_store_dwordx4 v[40:43], v140, s[8:11], s16 offen sc1
  s_sleep 2
  s_branch L_G
L_SPR:
  s_sleep 1
  buffer_load_dwordx4 v[96:99], v139, s[36:39], s18 offen offset:0 sc1
  buffer_load_dwordx4 v[100:103], v139, s[36:39], s18 offen offset:64 sc1
  buffer_load_dwordx4 v[104:107], v139, s[36:39], s18 offen offset:128 sc1
  buffer_load_dwordx4 v[108:111], v139, s[36:39], s18 offen offset:192 sc1
  s_sub_u32 s30, s30, 8
  s_cmp_gt_i32 s30, 0
  s_cbranch_scc1 L_SP0
  s_branch L_SPD
L_PHC:
  s_sleep 45
  s_branch L_CPS
L_GW:
W_44:
  ds_read_b32 v11, v3 offset:48
  s_waitcnt lgkmcnt(0)
  v_readfirstlane_b32 s31, v11
  s_cmp_ge_u32 s31, 4
  s_cbranch_scc1 W_45
  s_sleep 1
  s_sub_u32 s30, s30, 1
  s_cmp_gt_i32 s30, 0
  s_cbranch_scc1 W_44
W_45:
  s_branch L_G
L_GPR:
  s_sleep 1
  buffer_load_dwordx4 v[96:99], v18, s[36:39], s59 offen offset:0 sc1
  buffer_load_dwordx4 v[100:103], v18, s[36:39], s59 offen offset:64 sc1
  buffer_load_dwordx4 v[104:107], v18, s[36:39], s59 offen offset:128 sc1
  buffer_load_dwordx4 v[108:111], v18, s[36:39], s59 offen offset:192 sc1
  s_sub_u32 s30, s30, 8
  s_cmp_gt_i32 s30, 0
  s_cbranch_scc1 L_GP0
  s_branch L_GPD
L_GU:
  v_mov_b32 v40, s17
  v_mov_b32 v41, s17
  v_mov_b32 v42, s17
  v_mov_b32 v43, s17
W_46:
  ds_read_b32 v11, v3 offset:0
  s_waitcnt lgkmcnt(0)
  v_readfirstlane_b32 s31, v11
  s_cmp_ge_u32 s31, 310
  s_cbranch_scc1 W_47
  s_sleep 1
  s_sub_u32 s30, s30, 1
  s_cmp_gt_i32 s30, 0
  s_cbranch_scc1 W_46
W_47:
  ds_read_b64_tr_b16 v[64:65], v10 offset:0
  ds_read_b64_tr_b16 v[66:67], v10 offset:512
  ds_read_b64_tr_b16 v[68:69], v10 offset:4096
  ds_read_b64_tr_b16 v[70:71], v10 offset:4608
  ds_read_b64_tr_b16 v[72:73], v10 offset:8192
  ds_read_b64_tr_b16 v[74:75], v10 offset:8704
  ds_read_b64_tr_b16 v[76:77], v10 offset:12288
  ds_read_b64_tr_b16 v[78:79], v10 offset:12800
  s_waitcnt lgkmcnt(0)
  v_mfma_f32_16x16x32_bf16 v[44:47], v[64:67], v[40:43], 0
  v_mfma_f32_16x16x32_bf16 v[44:47], v[68:71], v[40:43], v[44:47]
  v_mfma_f32_16x16x32_bf16 v[44:47], v[72:75], v[40:43], v[44:47]
  v_mfma_f32_16x16x32_bf16 v[44:47], v[76:79], v[40:43], v[44:47]
  s_nop 7
  v_perm_b32 v44, v44, v15, s66
  v_perm_b32 v45, v45, v15, s67
  v_perm_b32 v46, v46, v15, s68
  v_perm_b32 v47, v47, v15, s69
  buffer_store_dwordx4 v[44:47], v8, s[4:7], s54 offen
  buffer_store_dwordx4 v[44:47], v8, s[8:11], s54 offen sc1
  s_mov_b64 exec, 1
  ds_add_u32 v3, v4 offset:40
  s_mov_b64 exec, -1
  s_setprio 2
W_48:
  ds_read_b32 v11, v3 offset:36
  s_waitcnt lgkmcnt(0)
  v_readfirstlane_b32 s31, v11
  s_cmp_ge_u32 s31, 1
  s_cbranch_scc1 W_49
  s_sub_u32 s30, s30, 1
  s_cmp_gt_i32 s30, 0
  s_cbranch_scc1 W_48
W_49:
  buffer_load_dwordx4 v[96:99], v18, s[36:39], s59 offen offset:0 sc1
  buffer_load_dwordx4 v[100:103], v18, s[36:39], s59 offen offset:64 sc1
  buffer_load_dwordx4 v[104:107], v18, s[36:39], s59 offen offset:128 sc1
  buffer_load_dwordx4 v[108:111], v18, s[36:39], s59 offen offset:192 sc1
L_GP0:
  s_waitcnt vmcnt(3)
  v_mfma_f32_16x16x32_bf16 v[40:43], v[64:67], v[96:99], 0
  v_max3_u32 v11, v96, v97, v98
  v_max_u32 v11, v11, v99
  s_waitcnt vmcnt(2)
  v_mfma_f32_16x16x32_bf16 v[40:43], v[68:71], v[100:103], v[40:43]
  v_max3_u32 v11, v11, v100, v101
  v_max3_u32 v11, v11, v102, v103
  s_waitcnt vmcnt(1)
  v_mfma_f32_16x16x32_bf16 v[40:43], v[72:75], v[104:107], v[40:43]
  v_max3_u32 v11, v11, v104, v105
  v_max3_u32 v11, v11, v106, v107
  s_waitcnt vmcnt(0)
  v_mfma_f32_16x16x32_bf16 v[40:43], v[76:79], v[108:111], v[40:43]
  v_max3_u32 v11, v11, v108, v109
  v_max3_u32 v11, v11, v110, v111
  v_cmp_eq_u32 vcc, -1, v11
  s_cbranch_vccnz L_GPR
L_GPD:
  s_nop 3
  v_perm_b32 v40, v40, v15, s66
  v_perm_b32 v41, v41, v15, s67
  v_perm_b32 v42, v42, v15, s68
  v_perm_b32 v43, v43, v15, s69
  buffer_store_dwordx4 v[40:43], v7, s[4:7], s53 offen
  buffer_store_dwordx4 v[40:43], v7, s[8:11], s53 offen sc1
  s_mov_b64 exec, 1
  ds_add_u32 v3, v4 offset:48
  s_mov_b64 exec, -1
  s_sleep 2
L_G:
  buffer_load_dwordx3 v[24:26], v29, s[36:39], s16 offen sc1
  buffer_load_dword v32, v22, s[36:39], s12 offen offset:0 sc1
  buffer_load_dword v33, v22, s[36:39], s12 offen offset:256 sc1
  buffer_load_dword v34, v22, s[36:39], s12 offen offset:512 sc1
  buffer_load_dword v35, v22, s[36:39], s12 offen offset:768 sc1
  buffer_load_dword v36, v22, s[36:39], s12 offen offset:1024 sc1
  buffer_load_dword v37, v22, s[36:39], s12 offen offset:1280 sc1
  buffer_load_dword v38, v22, s[36:39], s12 offen offset:1536 sc1
  buffer_load_dword v39, v22, s[36:39], s12 offen offset:1792 sc1
W_50:
  ds_read_b32 v11, v3 offset:56
  s_waitcnt lgkmcnt(0)
  v_readfirstlane_b32 s31, v11
  s_cmp_ge_u32 s31, 1
  s_cbranch_scc1 W_51
  s_sub_u32 s30, s30, 1
  s_cmp_gt_i32 s30, 0
  s_cbranch_scc1 W_50
W_51:
  ds_read_b64 v[46:47], v136
L_G2:
  s_waitcnt vmcnt(8)
  v_add_f32_dpp v24, v24, v24 quad_perm:[1,0,3,2] row_mask:0xf bank_mask:0xf
  v_add_f32_dpp v25, v25, v25 quad_perm:[1,0,3,2] row_mask:0xf bank_mask:0xf
  v_xor_b32 v26, s49, v26
  v_add_f32_dpp v24, v24, v24 quad_perm:[2,3,0,1] row_mask:0xf bank_mask:0xf
  v_add_f32_dpp v25, v25, v25 quad_perm:[2,3,0,1] row_mask:0xf bank_mask:0xf
  v_mul_f32 v24, 0x3b000000, v24
  v_mul_f32 v25, 0x3b000000, v25
  v_fma_f32 v25, -v24, v24, v25
  v_max_f32 v25, 0, v25
  v_cvt_pk_bf16_f32 v24, v24, v25
  v_and_b32 v25, 0xffff0000, v24
  v_lshlrev_b32 v24, 16, v24
  v_add_f32 v25, 0x3727c5ac, v25
  v_cvt_pk_bf16_f32 v25, v25, v25
  v_lshlrev_b32 v25, 16, v25
  v_sqrt_f32 v25, v25
  s_waitcnt vmcnt(0) lgkmcnt(0)
  v_xor_b32 v32, v17, v32
  v_cvt_pk_bf16_f32 v25, v25, v25
  v_xor_b32 v34, v17, v34
  v_lshlrev_b32 v25, 16, v25
  v_xor_b32 v36, v17, v36
  v_rcp_f32 v25, v25
  v_xor_b32 v38, v17, v38
  v_fma_f32 v44, -v24, v46, v32
  v_add_f32 v45, v34, v36
  v_add_f32 v44, v44, v38
  v_mul_f32 v27, 0xbfb8aa3b, v25
  v_add_f32 v44, v44, v45
  v_xor_b32 v33, v17, v33
  v_mul_f32 v44, v44, v27
  v_xor_b32 v35, v17, v35
  v_exp_f32 v44, v44
  v_xor_b32 v37, v17, v37
  v_xor_b32 v39, v17, v39
  v_add_f32 v44, 1.0, v44
  v_fma_f32 v45, -v24, v47, v33
  v_rcp_f32 v44, v44
  v_add_f32 v27, v35, v37
  v_add_f32 v45, v45, v39
  v_or3_b32 v11, v32, v33, v34
  v_add_f32 v45, v45, v27
  v_or3_b32 v11, v11, v35, v36
  v_mul_f32 v45, v45, v25
  v_or3_b32 v11, v11, v37, v38
  v_mul_f32 v44, v44, v45
  v_or_b32 v11, v11, v39
  v_cvt_pk_bf16_f32 v44, v44, v44
  v_and_or_b32 v11, v11, s19, v26
  ds_write_b16 v19, v44
  v_cmp_ne_u32 vcc, 0, v11
  s_cmp_ge_u32 s3, 2
  s_cbranch_vccnz L_GR
L_GD:
  s_waitcnt lgkmcnt(0)
  s_barrier
  s_cbranch_scc1 L_RC0
  ds_read_b128 v[48:51], v137
  ds_read_b128 v[52:55], v138
  ds_read_b128 v[56:59], v137 offset:64
  ds_read_b128 v[60:63], v138 offset:64
  s_waitcnt lgkmcnt(3)
  v_mfma_f32_16x16x32_bf16 v[32:35], v[64:67], v[48:51], 0
  s_waitcnt lgkmcnt(2)
  v_mfma_f32_16x16x32_bf16 v[32:35], v[72:75], v[52:55], v[32:35]
  s_waitcnt lgkmcnt(1)
  v_mfma_f32_16x16x32_bf16 v[32:35], v[68:71], v[56:59], v[32:35]
  s_waitcnt lgkmcnt(0)
  v_mfma_f32_16x16x32_bf16 v[32:35], v[76:79], v[60:63], v[32:35]
  s_nop 7
  v_perm_b32 v32, v32, v15, s66
  v_perm_b32 v33, v33, v15, s67
  v_perm_b32 v34, v34, v15, s68
  v_perm_b32 v35, v35, v15, s69
  buffer_store_dwordx4 v[32:35], v7, s[36:39], s52 offen sc1
  s_sleep 14
  s_mov_b64 exec, 1
  ds_add_u32 v3, v4 offset:44
  s_mov_b64 exec, -1
  s_branch L_FIN
L_GR:
  buffer_load_dwordx3 v[24:26], v29, s[36:39], s16 offen sc1
  buffer_load_dword v32, v22, s[36:39], s12 offen offset:0 sc1
  buffer_load_dword v33, v22, s[36:39], s12 offen offset:256 sc1
  buffer_load_dword v34, v22, s[36:39], s12 offen offset:512 sc1
  buffer_load_dword v35, v22, s[36:39], s12 offen offset:768 sc1
  buffer_load_dword v36, v22, s[36:39], s12 offen offset:1024 sc1
  buffer_load_dword v37, v22, s[36:39], s12 offen offset:1280 sc1
  buffer_load_dword v38, v22, s[36:39], s12 offen offset:1536 sc1
  buffer_load_dword v39, v22, s[36:39], s12 offen offset:1792 sc1
  s_sub_u32 s30, s30, 8
  s_cmp_gt_i32 s30, 0
  s_cbranch_scc1 L_G2
  s_cmp_ge_u32 s3, 2
  s_branch L_GD
L_CPR:
  s_sleep 1
  buffer_load_dwordx4 v[64:67], v7, s[36:39], s52 offen sc1
  buffer_load_dwordx4 v[68:71], v8, s[36:39], s52 offen offset:256 sc1
  s_sub_u32 s30, s30, 8
  s_cmp_gt_i32 s30, 0
  s_cbranch_scc1 L_CP0
  s_branch L_CPD
L_RC0:
  s_cmp_eq_u32 s3, 2
  s_cbranch_scc0 L_FIN
W_52:
  ds_read_b32 v11, v3 offset:44
  s_waitcnt lgkmcnt(0)
  v_readfirstlane_b32 s31, v11
  s_cmp_ge_u32 s31, 2
  s_cbranch_scc1 W_53
  s_sub_u32 s30, s30, 1
  s_cmp_gt_i32 s30, 0
  s_cbranch_scc1 W_52
W_53:
L_CPS:
  buffer_load_dwordx4 v[64:67], v7, s[36:39], s52 offen sc1
  buffer_load_dwordx4 v[68:71], v8, s[36:39], s52 offen offset:256 sc1
L_CP0:
  s_waitcnt vmcnt(1)
  v_xor_b32 v64, s62, v64
  v_xor_b32 v65, s63, v65
  v_xor_b32 v66, s64, v66
  v_xor_b32 v67, s65, v67
  v_or3_b32 v11, v64, v65, v66
  s_waitcnt vmcnt(0)
  v_xor_b32 v68, v60, v68
  v_xor_b32 v69, v61, v69
  v_xor_b32 v70, v62, v70
  v_xor_b32 v71, v63, v71
  v_add_f32 v40, v64, v68
  v_add_f32 v42, v66, v70
  v_add_f32 v41, v65, v69
  v_add_f32 v43, v67, v71
  v_permlane32_swap_b32 v40, v42
  v_or3_b32 v11, v11, v67, v68
  v_permlane32_swap_b32 v41, v43
  v_add_f32 v40, v40, v42
  v_add_f32 v41, v41, v43
  v_or3_b32 v11, v11, v69, v70
  v_or_b32 v11, v11, v71
  v_permlane16_swap_b32 v40, v41
  v_add_f32 v40, v40, v41
  v_and_b32 v11, 0xff, v11
  v_cmp_ne_u32 vcc, 0, v11
  v_add_f32_dpp v40, v40, v40 row_ror:4 row_mask:0xf bank_mask:0xf
  s_nop 0
  s_cbranch_vccnz L_CPR
L_CPD:
  v_add_f32_dpp v41, v40, v40 row_ror:8 row_mask:0xf bank_mask:0xf
  v_add_f32_dpp v40, v40, v40 row_ror:8 row_mask:0xf bank_mask:0xf
  s_nop 1
  v_permlane16_swap_b32 v40, v41
  v_cvt_pk_bf16_f32 v40, v40, v41
  v_and_b32 v41, 0xffff0000, v40
  v_lshlrev_b32 v40, 16, v40
  v_add_f32 v41, v41, v13
  v_add_f32 v40, v40, v12
  v_cvt_pk_bf16_f32 v40, v40, v41
  buffer_store_dword v40, v9, s[44:47], 0 offen
L_FIN:
L_LAST:
  s_endpgm
.section .rodata,"a"
.p2align 6
.amdhsa_kernel sequential_preLN__sliding_block_cached__glu_gated_glu__decode_kernel
  .amdhsa_next_free_vgpr 144
  .amdhsa_next_free_sgpr 102
  .amdhsa_accum_offset 144
  .amdhsa_float_denorm_mode_32 3
  .amdhsa_group_segment_fixed_size 0
  .amdhsa_kernarg_size 96
  .amdhsa_user_sgpr_count 2
  .amdhsa_user_sgpr_kernarg_segment_ptr 1
  .amdhsa_system_sgpr_workgroup_id_x 1
.end_amdhsa_kernel
```
